```python
import torch

def _softmax(x, axis=-1):
    return torch.softmax(x, dim=axis)
def _gelu(x):
    return torch.nn.functional.gelu(x, approximate="tanh")
def _silu(x):
    return torch.nn.functional.silu(x)
def _sigmoid(x):
    return torch.sigmoid(x)
def _layernorm(x, axis=-1, eps=1e-5):
    m = x.mean(dim=axis, keepdim=True)
    v = x.var(dim=axis, keepdim=True, unbiased=False)
    return (x - m) / torch.sqrt(v + eps)
def _scatter_add(tgt, idx, src, axis=0):
    return tgt.clone().index_add_(axis, idx, src)
def _segment_sum(src, seg, n):
    out = torch.zeros((n,) + src.shape[1:], dtype=src.dtype)
    return out.index_add_(0, seg, src)
def _pad(x, pw):
    flat = tuple(v for pair in reversed(pw) for v in pair)
    return torch.nn.functional.pad(x, flat)

kernel_name = 'interleave_layers__sliding_local_dilated__moe_arch_mod__prompt'

def setup_inputs():

    _w = (lambda a: (lambda t: t.to(torch.bfloat16) if t.is_floating_point() else t)(torch.as_tensor(a)))
    def _A_setup():
        B, S, D = 1, 2048, 512
        return {
            "x": _w((lambda *s: torch.randn(*s, dtype=torch.bfloat16) * 0.05)(B, S, D)),
            "wqkv": _w((lambda *s: torch.randn(*s, dtype=torch.bfloat16) * 0.05)(D, 3 * D)),
            "wo": _w((lambda *s: torch.randn(*s, dtype=torch.bfloat16) * 0.05)(D, D)),
        }
    _A_in = _A_setup()

    def _B_setup():
        B, S, D, F, C = 1, 2048, 512, 1376, 1
        return {
            "x": _w((lambda *s: torch.randn(*s, dtype=torch.bfloat16) * 0.05)(B, S, D)),
            "w_r": _w((lambda *s: torch.randn(*s, dtype=torch.bfloat16) * 0.05)(D)),
            "w_gate": _w((lambda *s: torch.randn(*s, dtype=torch.bfloat16) * 0.05)(D, F)),
            "w_up": _w((lambda *s: torch.randn(*s, dtype=torch.bfloat16) * 0.05)(D, F)),
            "w_down": _w((lambda *s: torch.randn(*s, dtype=torch.bfloat16) * 0.05)(F, D)),
        }
    _B_in = _B_setup()

    return {
        "A_x": _A_in["x"],
        "A_wqkv": _A_in["wqkv"],
        "A_wo": _A_in["wo"],
        "B_x": _B_in["x"],
        "B_w_r": _B_in["w_r"],
        "B_w_gate": _B_in["w_gate"],
        "B_w_up": _B_in["w_up"],
        "B_w_down": _B_in["w_down"],
    }

def reference(A_x, A_wqkv, A_wo, B_x, B_w_r, B_w_gate, B_w_up, B_w_down):
    def _A_ref(x, wqkv, wo):
        B, S, D = x.shape
        H = 32; Dh = D // H
        W, dil = 8, 2
        qkv = (lambda x, *d: x.permute(*d))((x @ wqkv).reshape(B, S, 3, H, Dh), 2, 0, 3, 1, 4)
        q, k, v = qkv[0], qkv[1], qkv[2]
        scale = Dh ** -0.5
        pos = torch.arange(S)
        off = torch.arange(W) * dil
        idx = pos[:, None] - off[None, :]
        mask = idx >= 0
        idx_c = torch.where(mask, idx, 0).reshape(-1)
        kg = k[:, :, idx_c, :].reshape(B, H, S, W, Dh)
        vg = v[:, :, idx_c, :].reshape(B, H, S, W, Dh)
        logits = torch.einsum("bhsd,bhswd->bhsw", q, kg) * scale
        logits = torch.where(mask[None, None, :, :], logits, -1e9)
        attn = _softmax(logits, axis=-1)
        o = torch.einsum("bhsw,bhswd->bhsd", attn, vg)
        return (lambda x, *d: x.permute(*d))(o, 0, 2, 1, 3).reshape(B, S, D) @ wo

    def _B_ref(x, w_r, w_gate, w_up, w_down):
        B, S, D = x.shape
        C = 1
        r = x @ w_r
        idx = torch.argsort(-r, axis=-1)[:, :C]
        idx_e = (lambda x, n, axis: torch.repeat_interleave(x, n, dim=axis))(idx.reshape(B, C, 1), D, axis=2)
        x_sel = (lambda x, i, axis: torch.take_along_dim(x, i, dim=axis))(x, idx_e, axis=1)
        g = _silu(x_sel @ w_gate)
        u = x_sel @ w_up
        y = (g * u) @ w_down
        r_sel = _sigmoid((lambda x, i, axis: torch.take_along_dim(x, i, dim=axis))(r, idx, axis=1))
        y = y * r_sel.reshape(B, C, 1)
        b_off = (torch.arange(B) * S).reshape(B, 1)
        flat_idx = (idx + b_off).reshape(B * C)
        zero = (x * 0.0).reshape(B * S, D)
        upd = _scatter_add(zero, flat_idx, y.reshape(B * C, D), axis=0)
        return x + upd.reshape(B, S, D)

    x = A_x
    x = x + _A_ref(_layernorm(x, axis=-1), A_wqkv, A_wo)
    x = x + _B_ref(_layernorm(x, axis=-1), B_w_r, B_w_gate, B_w_up, B_w_down)
    x = x + _A_ref(_layernorm(x, axis=-1), A_wqkv, A_wo)
    x = x + _B_ref(_layernorm(x, axis=-1), B_w_r, B_w_gate, B_w_up, B_w_down)
    return x
```

```asm
; @launch grid=(256,1,1) block=(256,1,1) lds=163840
.amdgcn_target "amdgcn-amd-amdhsa--gfx950"
.text
.p2align 12
.globl interleave_layers__sliding_local_dilated__moe_arch_mod__prompt_kernel
.p2align 8
.type interleave_layers__sliding_local_dilated__moe_arch_mod__prompt_kernel,@function
interleave_layers__sliding_local_dilated__moe_arch_mod__prompt_kernel:
    s_cmp_ge_u32 s2, 256
    s_cbranch_scc1 L_end
    s_load_dwordx2 s[4:5], s[0:1], 0
    s_load_dwordx2 s[8:9], s[0:1], 8
    s_load_dwordx2 s[16:17], s[0:1], 80
    s_load_dwordx2 s[12:13], s[0:1], 16
    s_load_dwordx2 s[36:37], s[0:1], 32
    s_getpc_b64 s[64:65]
L_pc:
    s_lshr_b32 s66, s2, 3
    v_and_b32 v196, 7, v0
    v_lshl_add_u32 v196, v196, 5, s66
    v_lshlrev_b32 v196, 7, v196
    v_min_u32 v196, L_last-L_pc, v196
    s_mov_b64 exec, 0xFF
    global_load_dword v204, v196, s[64:65]
    s_mov_b64 exec, -1
    v_lshrrev_b32 v196, 6, v0
    v_min_u32 v78, 1, v0
    v_and_b32 v0, 63, v0
    s_and_b32 s44, s2, 7
    v_readfirstlane_b32 s47, v196
    s_bfe_u32 s45, s2, 0x30003
    s_lshr_b32 s46, s2, 6
    s_mov_b32 s55, 0
    s_add_u32 s78, s44, s45
    s_and_b32 s78, s78, 7
    s_lshl_b32 s56, s78, 11
    s_mov_b32 s6, 2097152
    s_mov_b32 s7, 0x20000
    s_mov_b32 s10, 1572864
    s_mov_b32 s11, 0x20000
    s_mov_b32 s38, 1024
    s_mov_b32 s39, 0x20000
    s_lshr_b32 s64, s44, 1
    s_lshl_b32 s64, s64, 2
    s_add_u32 s64, s64, s46
    s_lshl_b32 s64, s64, 17
    s_and_b32 s65, s44, 1
    s_lshl_b32 s65, s65, 10
    s_add_u32 s80, s64, s65
    s_lshl_b32 s65, s47, 15
    s_add_u32 s65, s65, s80
    s_sub_u32 s66, s80, 16384
    s_cselect_b32 s66, 2147418112, s66
    s_mul_i32 s81, s47, 3072
    s_lshl_b32 s79, s47, 14
    s_lshl_b32 s86, s47, 10
    v_lshrrev_b32 v196, 3, v0
    v_and_b32 v197, 7, v0
    v_and_b32 v198, 6, v196
    v_xor_b32 v198, v198, v197
    v_lshlrev_b32 v198, 4, v198
    v_lshl_add_u32 v198, v196, 11, v198
    v_add_u32 v58, s65, v198
    v_add_u32 v63, s66, v198
    v_add_u32 v59, 15360, v58
    v_and_b32 v198, 2, v196
    v_xor_b32 v198, v198, v197
    s_and_b32 s64, s47, 1
    s_lshl_b32 s64, s64, 2
    v_xor_b32 v198, s64, v198
    s_lshl_b32 s65, s45, 7
    v_lshl_add_u32 v198, v198, 4, s65
    s_lshl_b32 s64, s47, 3
    v_add_u32 v199, s64, v196
    v_lshl_add_u32 v61, v199, 10, v198
    v_mul_u32_u24 v199, 3072, v199
    v_add_u32 v60, v199, v198
    v_add_u32 v72, 98304, v60
    s_add_u32 s67, s47, s78
    s_and_b32 s67, s67, 7
    s_lshl_b32 s87, s67, 7
    v_and_b32 v1, 15, v0
    v_lshrrev_b32 v2, 4, v0
    v_lshlrev_b32 v3, 4, v0
    v_and_b32 v216, 1, v2
    v_lshrrev_b32 v217, 1, v2
    v_lshl_add_u32 v218, v216, 1, v217
    v_lshl_add_u32 v199, v218, 4, s65
    s_waitcnt lgkmcnt(0)
    s_add_u32 m0, s79, 0
    s_lshr_b32 s3, s56, 4
    buffer_load_dwordx4 v58, s[4:7], s3 offen  lds
    s_load_dword s49, s[16:17], 0
    s_load_dwordx2 s[20:21], s[0:1], 64
    s_load_dwordx2 s[24:25], s[0:1], 40
    s_load_dwordx2 s[28:29], s[0:1], 48
    buffer_load_dwordx4 v59, s[4:7], s3 offen offset:1024  lds
    s_load_dwordx2 s[32:33], s[0:1], 56
    s_add_u32 s57, s56, 2048
    s_and_b32 s57, s57, 16383
    s_add_u32 s58, s57, 2048
    s_add_u32 m0, s81, 73728
    s_mul_i32 s3, s56, 96
    buffer_load_dwordx4 v60, s[8:11], s3 offen offset:0 lds
    s_and_b32 s58, s58, 16383
    s_lshr_b32 s64, s2, 3
    s_lshl_b32 s64, s64, 2
    s_add_u32 s64, s64, s47
    buffer_load_dwordx4 v60, s[8:11], s3 offen offset:1024 lds
    s_mul_i32 s64, s64, 12288
    s_add_u32 s64, s64, 384
    v_lshl_add_u32 v200, v0, 10, s64
    v_and_b32 v220, 7, v1
    buffer_load_dwordx4 v60, s[8:11], s3 offen offset:2048 lds
    v_lshlrev_b32 v220, 7, v220
    v_and_b32 v221, 6, v1
    v_xor_b32 v221, v221, v2
    v_lshl_add_u32 v220, v221, 4, v220
    s_add_u32 m0, s86, 65536
    s_xor_b32 s3, s87, 0
    buffer_load_dwordx4 v63, s[4:7], s3 offen lds
    v_xor_b32 v221, 64, v220
    v_lshrrev_b32 v222, 3, v1
    v_cmp_gt_u32 vcc, 8, v1
    v_lshl_add_u32 v4, v222, 10, v220
    s_add_u32 m0, s81, 86016
    s_mul_i32 s3, s56, 96
    buffer_load_dwordx4 v72, s[8:11], s3 offen offset:0 lds
    v_lshl_add_u32 v5, v222, 10, v221
    v_add_u32 v220, 65536, v220
    v_add_u32 v221, 65536, v221
    v_mov_b32 v223, 147456
    buffer_load_dwordx4 v72, s[8:11], s3 offen offset:1024 lds
    v_cndmask_b32 v6, v220, v223, vcc
    v_cndmask_b32 v7, v221, v223, vcc
    v_add_u32 v64, s79, v4
    v_add_u32 v65, s79, v5
    buffer_load_dwordx4 v72, s[8:11], s3 offen offset:2048 lds
    v_lshrrev_b32 v220, 2, v1
    v_and_b32 v221, 3, v1
    v_lshlrev_b32 v221, 3, v221
    v_lshl_add_u32 v221, v220, 7, v221
    buffer_load_dwordx4 v[208:211], v3, s[36:39], 0 offen
    v_lshl_or_b32 v222, v216, 1, v222
    v_lshl_add_u32 v221, v222, 5, v221
    v_add_u32 v221, 73728, v221
    s_lshl_b32 s64, s47, 5
    buffer_load_dwordx4 v[50:53], v199, s[36:39], 0 offen
    buffer_load_dwordx4 v[54:57], v199, s[36:39], 0 offen offset:64
    v_xor_b32 v62, s64, v221
    v_mul_u32_u24 v220, 3072, v2
    v_add_u32 v62, v62, v220
    v_lshl_add_u32 v8, v2, 10, v221
    v_mov_b32 v36, 0x3F803F80
    v_mov_b32 v37, 0x3F803F80
    v_mov_b32 v38, 0x3F803F80
    v_mov_b32 v39, 0x3F803F80
    v_and_b32 v220, 7, v0
    v_lshl_add_u32 v220, v220, 10, v223
    ds_write_b128 v220, v[36:39]
    s_mov_b64 exec, 0xFFF
    buffer_load_dword v204, v200, s[8:11], 0 offen
    s_mov_b64 exec, -1
    s_add_u32 s59, s58, 2048
    s_and_b32 s59, s59, 16383
    s_add_u32 s60, s59, 2048
    s_and_b32 s60, s60, 16383
    s_add_u32 s61, s60, 2048
    s_and_b32 s61, s61, 16383
    s_add_u32 s62, s61, 2048
    s_and_b32 s62, s62, 16383
    s_add_u32 s63, s62, 2048
    s_and_b32 s63, s63, 16383
    s_mov_b32 s18, 10485760
    s_mov_b32 s19, 0x20000
    s_mov_b32 s14, 524288
    s_mov_b32 s15, 0x20000
    s_mov_b32 s42, 196608
    s_mov_b32 s43, 0x20000
    s_mov_b32 s22, 2097152
    s_mov_b32 s23, 0x20000
    s_mov_b32 s26, 1409024
    s_mov_b32 s27, 0x20000
    s_mov_b32 s30, 1409024
    s_mov_b32 s31, 0x20000
    s_mov_b32 s34, 1409024
    s_mov_b32 s35, 0x20000
    s_lshl_b32 s48, s44, 2
    s_add_u32 s48, s48, s46
    s_lshl_b32 s64, s48, 18
    s_add_u32 s64, s64, 2097152
    s_add_u32 s40, s16, s64
    s_addc_u32 s41, s17, 0
    s_lshl_b32 s69, s45, 2
    s_add_u32 s69, s69, s47
    s_lshl_b32 s64, s48, 5
    s_add_u32 s64, s64, s69
    s_lshl_b32 s64, s64, 9
    s_add_u32 s64, s64, 524288
    v_lshl_add_u32 v202, v217, 30, s64
    v_add_u32 v202, v202, v3
    v_mov_b32 v212, -1
    v_mov_b32 v213, -1
    v_mov_b32 v214, -1
    v_mov_b32 v215, -1
    s_sub_u32 s64, s48, 1
    s_sub_u32 s65, s48, 5
    s_cmp_lt_u32 s44, 2
    s_cselect_b32 s65, 255, s65
    s_cmp_eq_u32 s46, 0
    s_cselect_b32 s52, s65, s64
    s_mov_b32 s53, 400000
    s_mov_b32 s72, 0xAAAAAAAA
    s_mov_b32 s73, 0xAAAAAAAA
    s_mov_b32 s74, 0xCCCCCCCC
    s_mov_b32 s75, 0xCCCCCCCC
    s_mov_b32 s76, 0x00F0000F
    s_mov_b32 s77, 0xF0000F00
    s_sub_u32 s64, s45, 2
    s_mul_i32 s65, s44, 6
    s_add_u32 s65, s65, s64
    s_cmp_lt_u32 s64, 6
    s_cselect_b32 s65, s65, 255
    s_cmp_eq_u32 s46, 2
    s_cselect_b32 s51, s65, 255
    s_cmp_lt_u32 s51, 43
    s_cselect_b32 s26, 1409024, 0
    s_mov_b32 s30, s26
    s_lshl_b32 s91, s47, 13
    s_mul_i32 s64, s47, 352256
    s_lshl_b32 s82, s51, 6
    s_add_u32 s82, s82, s64
    s_mov_b32 s90, 0
    s_mov_b32 s84, 32768
    s_min_u32 s65, s52, s48
    s_lshl_b32 s65, s65, 14
    s_add_u32 s65, s65, 524288
    v_add_u32 v83, s65, v3
    s_lshl1_add_u32 s65, s47, s78
    s_add_u32 s64, s65, 1
    s_and_b32 s65, s65, 7
    s_and_b32 s64, s64, 7
    s_lshl_b32 s92, s65, 10
    s_lshl_b32 s93, s64, 10
    s_lshl_b32 s64, s48, 3
    v_and_b32 v220, 7, v0
    v_add_lshl_u32 v69, v220, s64, 7
    s_add_u32 s64, s64, s45
    s_lshl_b32 s64, s64, 7
    v_lshl_add_u32 v78, v78, 30, s64
    s_sub_u32 s64, s45, s78
    s_and_b32 s64, s64, 7
    s_lshl_b32 s64, s64, 11
    s_add_u32 s85, s64, s79
    s_cmp_eq_u32 s52, 255
    s_cselect_b32 s88, 4286578688, 0
    s_getreg_b32 s50, hwreg(HW_REG_XCC_ID)
    s_and_b32 s50, s50, 15
    v_mov_b32 v81, s50
    s_waitcnt lgkmcnt(0)
    s_lshr_b32 s49, s49, 3
    s_mul_i32 s49, s49, 1664525
    s_add_u32 s49, s49, 1013904223
    s_lshl_b32 s49, s49, 3
    v_mov_b32 v80, s49
    s_lshr_b32 s64, s2, 3
    s_cmp_ge_u32 s47, 2
    s_cbranch_scc1 L_ft2
    s_cmp_eq_u32 s47, 0
    s_cselect_b32 s36, s24, s28
    s_cselect_b32 s37, s25, s29
    s_mov_b32 s38, 1409024
    s_mul_i32 s64, s64, 44032
    s_mul_i32 s66, s44, 384
    s_add_u32 s64, s64, s66
    v_lshrrev_b32 v74, 2, v0
    v_mul_u32_u24 v74, 2752, v74
    v_and_b32 v220, 3, v0
    v_lshlrev_b32 v220, 7, v220
    v_min_u32 v220, 380, v220
    v_add3_u32 v74, v74, v220, s64
    s_branch L_ftd
L_ft2:
    s_mul_i32 s64, s64, 6144
    s_mul_i32 s66, s44, 196608
    s_add_u32 s64, s64, s66
    s_add_u32 s64, s64, s81
    s_sub_u32 s64, s64, 6144
    s_mov_b32 s36, s32
    s_mov_b32 s37, s33
    s_mov_b32 s38, 1409024
    v_min_u32 v74, 23, v0
    v_lshl_add_u32 v74, v74, 7, s64
L_ftd:
    s_lshl_b32 s65, s69, 9
    s_lshl_b32 s66, s45, 11
    s_add_u32 s66, s66, s79
    s_add_u32 s66, s66, 131072
    s_lshl_b32 s67, s47, 8
    s_add_u32 s67, s67, 65536
    s_lshl_b32 s68, s45, 10
    s_lshl_b32 s83, s45, 7
    s_add_u32 s83, s83, 73728
    s_lshl_b32 s69, s47, 6
    s_add_u32 m0, s79, 2048
    s_lshr_b32 s3, s57, 4
    buffer_load_dwordx4 v58, s[4:7], s3 offen  lds
    buffer_load_dwordx4 v59, s[4:7], s3 offen offset:1024  lds
    s_add_u32 m0, s81, 98304
    s_mul_i32 s3, s57, 96
    buffer_load_dwordx4 v60, s[8:11], s3 offen offset:0 lds
    buffer_load_dwordx4 v60, s[8:11], s3 offen offset:1024 lds
    buffer_load_dwordx4 v60, s[8:11], s3 offen offset:2048 lds
    s_waitcnt vmcnt(12) lgkmcnt(0)
    s_barrier
    ds_read_b128 a[192:195], v6 offset:0
    ds_read_b128 a[196:199], v4 offset:0
    ds_read_b128 a[200:203], v4 offset:16384
    ds_read_b128 a[204:207], v4 offset:32768
    ds_read_b128 a[208:211], v4 offset:49152
    ds_read_b128 a[212:215], v64 offset:0
    ds_read_b64_tr_b16 a[0:1], v62 offset:0
    ds_read_b64_tr_b16 a[2:3], v62 offset:512
    ds_read_b64_tr_b16 a[4:5], v62 offset:1024
    ds_read_b64_tr_b16 a[6:7], v62 offset:1536
    ds_read_b64_tr_b16 a[8:9], v62 offset:2048
    ds_read_b64_tr_b16 a[10:11], v62 offset:2560
    s_waitcnt vmcnt(9) lgkmcnt(0)
    s_barrier
    v_mfma_f32_16x16x32_bf16 v[184:187], a[212:215], a[212:215], 0
    s_add_u32 m0, s81, 110592
    s_mul_i32 s3, s57, 96
    v_mfma_f32_16x16x32_bf16 v[188:191], v[36:39], a[212:215], 0
    buffer_load_dwordx4 v72, s[8:11], s3 offen offset:0 lds
    ds_read_b128 a[216:219], v7 offset:0
    v_mfma_f32_16x16x32_bf16 v[192:195], a[192:195], a[192:195], 0
    ds_read_b64_tr_b16 a[12:13], v62 offset:12288
    ds_read_b128 a[220:223], v5 offset:0
    v_mfma_f32_16x16x32_bf16 v[124:127], a[0:3], a[192:195], 0
    buffer_load_dwordx4 v72, s[8:11], s3 offen offset:1024 lds
    ds_read_b64_tr_b16 a[14:15], v62 offset:12800
    v_mfma_f32_16x16x32_bf16 v[128:131], a[4:7], a[192:195], 0
    ds_read_b128 a[224:227], v5 offset:16384
    ds_read_b64_tr_b16 a[16:17], v62 offset:13312
    v_mfma_f32_16x16x32_bf16 v[136:139], a[0:3], a[196:199], 0
    buffer_load_dwordx4 v72, s[8:11], s3 offen offset:2048 lds
    ds_read_b128 a[228:231], v5 offset:32768
    v_mfma_f32_16x16x32_bf16 v[140:143], a[4:7], a[196:199], 0
    s_add_u32 m0, s79, 4096
    s_lshr_b32 s3, s58, 4
    v_mfma_f32_16x16x32_bf16 v[148:151], a[0:3], a[200:203], 0
    buffer_load_dwordx4 v58, s[4:7], s3 offen  lds
    ds_read_b64_tr_b16 a[18:19], v62 offset:13824
    v_mfma_f32_16x16x32_bf16 v[152:155], a[4:7], a[200:203], 0
    ds_read_b128 a[232:235], v5 offset:49152
    v_mfma_f32_16x16x32_bf16 v[160:163], a[0:3], a[204:207], 0
    buffer_load_dwordx4 v59, s[4:7], s3 offen offset:1024  lds
    ds_read_b64_tr_b16 a[20:21], v62 offset:14336
    v_mfma_f32_16x16x32_bf16 v[164:167], a[4:7], a[204:207], 0
    s_add_u32 m0, s81, 122880
    s_mul_i32 s3, s58, 96
    v_mfma_f32_16x16x32_bf16 v[172:175], a[0:3], a[208:211], 0
    buffer_load_dwordx4 v60, s[8:11], s3 offen offset:0 lds
    ds_read_b128 a[236:239], v65 offset:0
    v_mfma_f32_16x16x32_bf16 v[176:179], a[4:7], a[208:211], 0
    ds_read_b64_tr_b16 a[22:23], v62 offset:14848
    v_mfma_f32_16x16x32_bf16 v[132:135], a[192:195], a[8:11], 0
    buffer_load_dwordx4 v60, s[8:11], s3 offen offset:1024 lds
    v_mfma_f32_16x16x32_bf16 v[144:147], a[196:199], a[8:11], 0
    v_mfma_f32_16x16x32_bf16 v[156:159], a[200:203], a[8:11], 0
    buffer_load_dwordx4 v60, s[8:11], s3 offen offset:2048 lds
    v_mfma_f32_16x16x32_bf16 v[168:171], a[204:207], a[8:11], 0
    v_mfma_f32_16x16x32_bf16 v[180:183], a[208:211], a[8:11], 0
    s_waitcnt vmcnt(8) lgkmcnt(0)
    s_barrier
    v_mfma_f32_16x16x32_bf16 v[184:187], a[236:239], a[236:239], v[184:187]
    s_add_u32 m0, s81, 135168
    s_mul_i32 s3, s58, 96
    v_mfma_f32_16x16x32_bf16 v[188:191], v[36:39], a[236:239], v[188:191]
    buffer_load_dwordx4 v72, s[8:11], s3 offen offset:0 lds
    ds_read_b128 a[192:195], v6 offset:1024
    v_mfma_f32_16x16x32_bf16 v[192:195], a[216:219], a[216:219], v[192:195]
    ds_read_b64_tr_b16 a[24:25], v62 offset:24576
    ds_read_b128 a[196:199], v4 offset:2048
    v_mfma_f32_16x16x32_bf16 v[124:127], a[12:15], a[216:219], v[124:127]
    buffer_load_dwordx4 v72, s[8:11], s3 offen offset:1024 lds
    ds_read_b64_tr_b16 a[26:27], v62 offset:25088
    v_mfma_f32_16x16x32_bf16 v[128:131], a[16:19], a[216:219], v[128:131]
    ds_read_b128 a[200:203], v4 offset:18432
    ds_read_b64_tr_b16 a[28:29], v62 offset:25600
    v_mfma_f32_16x16x32_bf16 v[136:139], a[12:15], a[220:223], v[136:139]
    buffer_load_dwordx4 v72, s[8:11], s3 offen offset:2048 lds
    ds_read_b128 a[204:207], v4 offset:34816
    v_mfma_f32_16x16x32_bf16 v[140:143], a[16:19], a[220:223], v[140:143]
    s_add_u32 m0, s79, 6144
    s_lshr_b32 s3, s59, 4
    v_mfma_f32_16x16x32_bf16 v[148:151], a[12:15], a[224:227], v[148:151]
    buffer_load_dwordx4 v58, s[4:7], s3 offen  lds
    ds_read_b64_tr_b16 a[30:31], v62 offset:26112
    v_mfma_f32_16x16x32_bf16 v[152:155], a[16:19], a[224:227], v[152:155]
    ds_read_b128 a[208:211], v4 offset:51200
    v_lshlrev_b32 v219, 4, v1
    v_mfma_f32_16x16x32_bf16 v[160:163], a[12:15], a[228:231], v[160:163]
    buffer_load_dwordx4 v59, s[4:7], s3 offen offset:1024  lds
    ds_read_b64_tr_b16 a[32:33], v62 offset:26624
    v_mfma_f32_16x16x32_bf16 v[164:167], a[16:19], a[228:231], v[164:167]
    s_add_u32 m0, s81, 73728
    s_mul_i32 s3, s59, 96
    v_mfma_f32_16x16x32_bf16 v[172:175], a[12:15], a[232:235], v[172:175]
    buffer_load_dwordx4 v60, s[8:11], s3 offen offset:0 lds
    ds_read_b128 a[212:215], v64 offset:2048
    v_mfma_f32_16x16x32_bf16 v[176:179], a[16:19], a[232:235], v[176:179]
    ds_read_b64_tr_b16 a[34:35], v62 offset:27136
    v_lshl_add_u32 v12, v217, 8, v219
    v_mfma_f32_16x16x32_bf16 v[132:135], a[216:219], a[20:23], v[132:135]
    buffer_load_dwordx4 v60, s[8:11], s3 offen offset:1024 lds
    v_lshl_add_u32 v12, v216, 14, v12
    v_mfma_f32_16x16x32_bf16 v[144:147], a[220:223], a[20:23], v[144:147]
    v_add_u32 v12, s65, v12
    v_add_u32 v13, s79, v3
    v_mfma_f32_16x16x32_bf16 v[156:159], a[224:227], a[20:23], v[156:159]
    buffer_load_dwordx4 v60, s[8:11], s3 offen offset:2048 lds
    v_lshl_add_u32 v14, v218, 8, v219
    v_mfma_f32_16x16x32_bf16 v[168:171], a[228:231], a[20:23], v[168:171]
    v_add_u32 v14, s66, v14
    v_add_u32 v16, s67, v219
    v_mfma_f32_16x16x32_bf16 v[180:183], a[232:235], a[20:23], v[180:183]
    s_waitcnt vmcnt(13) lgkmcnt(0)
    s_barrier
    v_mfma_f32_16x16x32_bf16 v[184:187], a[212:215], a[212:215], v[184:187]
    ds_read_b128 a[216:219], v7 offset:1024
    ds_read_b64_tr_b16 a[36:37], v62 offset:36864
    v_mfma_f32_16x16x32_bf16 v[188:191], v[36:39], a[212:215], v[188:191]
    buffer_store_dwordx4 v[212:215], v202, s[16:19], 0 offen sc1
    ds_read_b128 a[220:223], v5 offset:2048
    v_mfma_f32_16x16x32_bf16 v[192:195], a[192:195], a[192:195], v[192:195]
    ds_read_b64_tr_b16 a[38:39], v62 offset:37376
    v_add_u32 v15, s68, v16
    v_mfma_f32_16x16x32_bf16 v[124:127], a[24:27], a[192:195], v[124:127]
    s_add_u32 m0, s86, 69632
    s_xor_b32 s3, s87, 512
    v_mfma_f32_16x16x32_bf16 v[128:131], a[28:31], a[192:195], v[128:131]
    buffer_load_dwordx4 v63, s[4:7], s3 offen lds
    ds_read_b128 a[224:227], v5 offset:18432
    v_mfma_f32_16x16x32_bf16 v[136:139], a[24:27], a[196:199], v[136:139]
    ds_read_b64_tr_b16 a[40:41], v62 offset:37888
    v_lshl_add_u32 v16, v2, 10, v16
    v_mfma_f32_16x16x32_bf16 v[140:143], a[28:31], a[196:199], v[140:143]
    s_add_u32 m0, s81, 86016
    s_mul_i32 s3, s59, 96
    v_mfma_f32_16x16x32_bf16 v[148:151], a[24:27], a[200:203], v[148:151]
    buffer_load_dwordx4 v72, s[8:11], s3 offen offset:0 lds
    ds_read_b128 a[228:231], v5 offset:34816
    v_mfma_f32_16x16x32_bf16 v[152:155], a[28:31], a[200:203], v[152:155]
    ds_read_b64_tr_b16 a[42:43], v62 offset:38400
    v_and_b32 v82, 112, v219
    v_mfma_f32_16x16x32_bf16 v[160:163], a[24:27], a[204:207], v[160:163]
    ds_read_b128 a[232:235], v5 offset:51200
    v_add_u32 v82, s83, v82
    v_mfma_f32_16x16x32_bf16 v[164:167], a[28:31], a[204:207], v[164:167]
    ds_read_b64_tr_b16 a[44:45], v62 offset:38912
    v_cmp_eq_u32 vcc, 0, v2
    v_mfma_f32_16x16x32_bf16 v[172:175], a[24:27], a[208:211], v[172:175]
    buffer_load_dwordx4 v72, s[8:11], s3 offen offset:1024 lds
    ds_read_b128 a[236:239], v65 offset:2048
    v_mfma_f32_16x16x32_bf16 v[176:179], a[28:31], a[208:211], v[176:179]
    ds_read_b64_tr_b16 a[46:47], v62 offset:39424
    v_lshlrev_b32 v17, 2, v1
    v_mfma_f32_16x16x32_bf16 v[132:135], a[192:195], a[32:35], v[132:135]
    v_cndmask_b32 v82, v82, v15, vcc
    v_add_u32 v17, 147520, v17
    v_mfma_f32_16x16x32_bf16 v[144:147], a[196:199], a[32:35], v[144:147]
    buffer_load_dwordx4 v72, s[8:11], s3 offen offset:2048 lds
    v_lshlrev_b32 v18, 4, v2
    v_mfma_f32_16x16x32_bf16 v[156:159], a[200:203], a[32:35], v[156:159]
    v_add_u32 v18, 147520, v18
    v_add_u32 v73, 32768, v61
    v_mfma_f32_16x16x32_bf16 v[168:171], a[204:207], a[32:35], v[168:171]
    v_add_u32 v220, s69, v17
    v_add_u32 v221, 2048, v17
    v_mfma_f32_16x16x32_bf16 v[180:183], a[208:211], a[32:35], v[180:183]
    s_waitcnt vmcnt(13) lgkmcnt(0)
    s_barrier
    v_mfma_f32_16x16x32_bf16 v[184:187], a[236:239], a[236:239], v[184:187]
    s_add_u32 m0, s79, 8192
    s_lshr_b32 s3, s60, 4
    v_mfma_f32_16x16x32_bf16 v[188:191], v[36:39], a[236:239], v[188:191]
    buffer_load_dwordx4 v58, s[4:7], s3 offen  lds
    ds_read_b128 a[192:195], v6 offset:2048
    v_mfma_f32_16x16x32_bf16 v[192:195], a[216:219], a[216:219], v[192:195]
    ds_read_b64_tr_b16 a[48:49], v62 offset:49152
    ds_read_b128 a[196:199], v4 offset:4096
    v_mfma_f32_16x16x32_bf16 v[124:127], a[36:39], a[216:219], v[124:127]
    buffer_load_dwordx4 v59, s[4:7], s3 offen offset:1024  lds
    ds_read_b64_tr_b16 a[50:51], v62 offset:49664
    v_mfma_f32_16x16x32_bf16 v[128:131], a[40:43], a[216:219], v[128:131]
    ds_read_b128 a[200:203], v4 offset:20480
    v_cndmask_b32 v76, v221, v220, s[76:77]
    v_mfma_f32_16x16x32_bf16 v[136:139], a[36:39], a[220:223], v[136:139]
    s_add_u32 m0, s81, 98304
    s_mul_i32 s3, s60, 96
    v_mfma_f32_16x16x32_bf16 v[140:143], a[40:43], a[220:223], v[140:143]
    buffer_load_dwordx4 v60, s[8:11], s3 offen offset:0 lds
    ds_read_b64_tr_b16 a[52:53], v62 offset:50176
    v_mfma_f32_16x16x32_bf16 v[148:151], a[36:39], a[224:227], v[148:151]
    ds_read_b128 a[204:207], v4 offset:36864
    v_cndmask_b32 v77, v221, v17, s[76:77]
    v_mfma_f32_16x16x32_bf16 v[152:155], a[40:43], a[224:227], v[152:155]
    ds_read_b64_tr_b16 a[54:55], v62 offset:50688
    v_lshrrev_b32 v220, 3, v1
    v_mfma_f32_16x16x32_bf16 v[160:163], a[36:39], a[228:231], v[160:163]
    buffer_load_dwordx4 v60, s[8:11], s3 offen offset:1024 lds
    ds_read_b128 a[208:211], v4 offset:53248
    v_mfma_f32_16x16x32_bf16 v[164:167], a[40:43], a[228:231], v[164:167]
    ds_read_b64_tr_b16 a[56:57], v62 offset:51200
    v_and_b32 v221, 7, v1
    v_mfma_f32_16x16x32_bf16 v[172:175], a[36:39], a[232:235], v[172:175]
    ds_read_b128 a[212:215], v64 offset:4096
    v_lshlrev_b32 v221, 7, v221
    v_mfma_f32_16x16x32_bf16 v[176:179], a[40:43], a[232:235], v[176:179]
    buffer_load_dwordx4 v60, s[8:11], s3 offen offset:2048 lds
    ds_read_b64_tr_b16 a[58:59], v62 offset:51712
    v_mfma_f32_16x16x32_bf16 v[132:135], a[216:219], a[44:47], v[132:135]
    v_lshl_add_u32 v220, v220, 10, v221
    v_and_b32 v221, 6, v1
    v_mfma_f32_16x16x32_bf16 v[144:147], a[220:223], a[44:47], v[144:147]
    s_mov_b32 s64, 65536
    v_lshl_add_u32 v220, v221, 4, v220
    v_mfma_f32_16x16x32_bf16 v[156:159], a[224:227], a[44:47], v[156:159]
    buffer_store_dwordx2 v[80:81], v78, s[16:19], s64 offen sc1
    v_lshl_add_u32 v220, v2, 3, v220
    v_mfma_f32_16x16x32_bf16 v[168:171], a[228:231], a[44:47], v[168:171]
    v_add_u32 v248, s85, v220
    v_xor_b32 v249, 32, v248
    v_mfma_f32_16x16x32_bf16 v[180:183], a[232:235], a[44:47], v[180:183]
    s_waitcnt vmcnt(16) lgkmcnt(0)
    s_barrier
    v_mfma_f32_16x16x32_bf16 v[184:187], a[212:215], a[212:215], v[184:187]
    s_add_u32 m0, s81, 110592
    s_mul_i32 s3, s60, 96
    v_mfma_f32_16x16x32_bf16 v[188:191], v[36:39], a[212:215], v[188:191]
    buffer_load_dwordx4 v72, s[8:11], s3 offen offset:0 lds
    ds_read_b128 a[216:219], v7 offset:2048
    v_mfma_f32_16x16x32_bf16 v[192:195], a[192:195], a[192:195], v[192:195]
    ds_read_b64_tr_b16 a[60:61], v62 offset:61440
    v_xor_b32 v250, 64, v248
    v_mfma_f32_16x16x32_bf16 v[124:127], a[48:51], a[192:195], v[124:127]
    ds_read_b128 a[220:223], v5 offset:4096
    v_xor_b32 v251, 96, v248
    v_mfma_f32_16x16x32_bf16 v[128:131], a[52:55], a[192:195], v[128:131]
    ds_read_b64_tr_b16 a[62:63], v62 offset:61952
    v_xor_b32 v9, 32, v8
    v_mfma_f32_16x16x32_bf16 v[136:139], a[48:51], a[196:199], v[136:139]
    ds_read_b128 a[224:227], v5 offset:20480
    v_xor_b32 v10, 64, v8
    v_mfma_f32_16x16x32_bf16 v[140:143], a[52:55], a[196:199], v[140:143]
    buffer_load_dwordx4 v72, s[8:11], s3 offen offset:1024 lds
    ds_read_b64_tr_b16 a[64:65], v62 offset:62464
    v_mfma_f32_16x16x32_bf16 v[148:151], a[48:51], a[200:203], v[148:151]
    ds_read_b128 a[228:231], v5 offset:36864
    v_xor_b32 v11, 96, v8
    v_mfma_f32_16x16x32_bf16 v[152:155], a[52:55], a[200:203], v[152:155]
    ds_read_b64_tr_b16 a[66:67], v62 offset:62976
    v_lshrrev_b32 v122, 2, v0
    v_mfma_f32_16x16x32_bf16 v[160:163], a[48:51], a[204:207], v[160:163]
    ds_read_b128 a[232:235], v5 offset:53248
    v_mul_u32_u24 v122, 2752, v122
    v_mfma_f32_16x16x32_bf16 v[164:167], a[52:55], a[204:207], v[164:167]
    ds_read_b64_tr_b16 a[68:69], v62 offset:63488
    v_and_b32 v220, 3, v0
    v_mfma_f32_16x16x32_bf16 v[172:175], a[48:51], a[208:211], v[172:175]
    ds_read_b128 a[236:239], v65 offset:4096
    v_and_b32 v221, 2, v2
    v_mfma_f32_16x16x32_bf16 v[176:179], a[52:55], a[208:211], v[176:179]
    buffer_load_dwordx4 v72, s[8:11], s3 offen offset:2048 lds
    ds_read_b64_tr_b16 a[70:71], v62 offset:64000
    v_mfma_f32_16x16x32_bf16 v[132:135], a[192:195], a[56:59], v[132:135]
    v_xor_b32 v221, v220, v221
    v_lshl_add_u32 v122, v221, 4, v122
    v_mfma_f32_16x16x32_bf16 v[144:147], a[196:199], a[56:59], v[144:147]
    v_add_u32 v122, s82, v122
    v_lshrrev_b32 v123, 2, v1
    v_mfma_f32_16x16x32_bf16 v[156:159], a[200:203], a[56:59], v[156:159]
    v_lshlrev_b32 v123, 6, v123
    v_lshl_add_u32 v123, v2, 9, v123
    v_mfma_f32_16x16x32_bf16 v[168:171], a[204:207], a[56:59], v[168:171]
    v_lshl_add_u32 v123, v220, 3, v123
    v_lshl_add_u32 v123, v216, 5, v123
    v_mfma_f32_16x16x32_bf16 v[180:183], a[208:211], a[56:59], v[180:183]
    s_waitcnt vmcnt(14) lgkmcnt(0)
    s_barrier
    v_mfma_f32_16x16x32_bf16 v[184:187], a[236:239], a[236:239], v[184:187]
    s_add_u32 m0, s79, 10240
    s_lshr_b32 s3, s61, 4
    v_mfma_f32_16x16x32_bf16 v[188:191], v[36:39], a[236:239], v[188:191]
    buffer_load_dwordx4 v58, s[4:7], s3 offen  lds
    ds_read_b128 a[192:195], v6 offset:3072
    v_mfma_f32_16x16x32_bf16 v[192:195], a[216:219], a[216:219], v[192:195]
    ds_read_b64_tr_b16 a[72:73], v62 offset:0
    ds_read_b128 a[196:199], v4 offset:6144
    v_mfma_f32_16x16x32_bf16 v[124:127], a[60:63], a[216:219], v[124:127]
    ds_read_b64_tr_b16 a[74:75], v62 offset:512
    v_add_u32 v123, s91, v123
    v_mfma_f32_16x16x32_bf16 v[128:131], a[64:67], a[216:219], v[128:131]
    buffer_load_dwordx4 v59, s[4:7], s3 offen offset:1024  lds
    ds_read_b128 a[200:203], v4 offset:22528
    v_mfma_f32_16x16x32_bf16 v[136:139], a[60:63], a[220:223], v[136:139]
    ds_read_b64_tr_b16 a[76:77], v62 offset:1024
    v_lshlrev_b32 v220, 2, v2
    v_mfma_f32_16x16x32_bf16 v[140:143], a[64:67], a[220:223], v[140:143]
    s_add_u32 m0, s81, 122880
    s_mul_i32 s3, s61, 96
    v_mfma_f32_16x16x32_bf16 v[148:151], a[60:63], a[224:227], v[148:151]
    buffer_load_dwordx4 v60, s[8:11], s3 offen offset:0 lds
    ds_read_b128 a[204:207], v4 offset:38912
    v_mfma_f32_16x16x32_bf16 v[152:155], a[64:67], a[224:227], v[152:155]
    ds_read_b64_tr_b16 a[78:79], v62 offset:1536
    v_sub_u32 v220, v220, v1
    v_mfma_f32_16x16x32_bf16 v[160:163], a[60:63], a[228:231], v[160:163]
    ds_read_b128 a[208:211], v4 offset:55296
    v_mov_b32 v221, 4286578688
    v_mfma_f32_16x16x32_bf16 v[164:167], a[64:67], a[228:231], v[164:167]
    ds_read_b64_tr_b16 a[80:81], v62 offset:2048
    v_cmp_le_i32 vcc, 9, v220
    v_mfma_f32_16x16x32_bf16 v[172:175], a[60:63], a[232:235], v[172:175]
    buffer_load_dwordx4 v60, s[8:11], s3 offen offset:1024 lds
    ds_read_b128 a[212:215], v64 offset:6144
    v_mfma_f32_16x16x32_bf16 v[176:179], a[64:67], a[232:235], v[176:179]
    ds_read_b64_tr_b16 a[82:83], v62 offset:2560
    v_add_u32 v222, 7, v220
    v_mfma_f32_16x16x32_bf16 v[132:135], a[216:219], a[68:71], v[132:135]
    v_cndmask_b32 v22, v221, 0, vcc
    v_cmp_ge_u32 vcc, 7, v222
    v_mfma_f32_16x16x32_bf16 v[144:147], a[220:223], a[68:71], v[144:147]
    buffer_load_dwordx4 v60, s[8:11], s3 offen offset:2048 lds
    v_or_b32 v30, s88, v22
    v_mfma_f32_16x16x32_bf16 v[156:159], a[224:227], a[68:71], v[156:159]
    v_cndmask_b32 v26, v221, 0, vcc
    v_cmp_le_i32 vcc, 8, v220
    v_mfma_f32_16x16x32_bf16 v[168:171], a[228:231], a[68:71], v[168:171]
    v_add_u32 v222, 8, v220
    v_cndmask_b32 v23, v221, 0, vcc
    v_mfma_f32_16x16x32_bf16 v[180:183], a[232:235], a[68:71], v[180:183]
    s_waitcnt vmcnt(14) lgkmcnt(0)
    s_barrier
    v_mfma_f32_16x16x32_bf16 v[184:187], a[212:215], a[212:215], v[184:187]
    s_add_u32 m0, s79, 14336
    s_lshr_b32 s3, s63, 4
    v_mfma_f32_16x16x32_bf16 v[188:191], v[36:39], a[212:215], v[188:191]
    buffer_load_dwordx4 v58, s[4:7], s3 offen  lds
    ds_read_b128 a[216:219], v7 offset:3072
    v_mfma_f32_16x16x32_bf16 v[192:195], a[192:195], a[192:195], v[192:195]
    ds_read_b64_tr_b16 a[84:85], v62 offset:12288
    ds_read_b128 a[220:223], v5 offset:6144
    v_mfma_f32_16x16x32_bf16 v[124:127], a[72:75], a[192:195], v[124:127]
    ds_read_b64_tr_b16 a[86:87], v62 offset:12800
    v_cmp_ge_u32 vcc, 7, v222
    v_mfma_f32_16x16x32_bf16 v[128:131], a[76:79], a[192:195], v[128:131]
    buffer_load_dwordx4 v59, s[4:7], s3 offen offset:1024  lds
    ds_read_b128 a[224:227], v5 offset:22528
    v_mfma_f32_16x16x32_bf16 v[136:139], a[72:75], a[196:199], v[136:139]
    ds_read_b64_tr_b16 a[88:89], v62 offset:13312
    v_or_b32 v31, s88, v23
    v_mfma_f32_16x16x32_bf16 v[140:143], a[76:79], a[196:199], v[140:143]
    s_add_u32 m0, s81, 135168
    s_mul_i32 s3, s61, 96
    v_mfma_f32_16x16x32_bf16 v[148:151], a[72:75], a[200:203], v[148:151]
    buffer_load_dwordx4 v72, s[8:11], s3 offen offset:0 lds
    ds_read_b128 a[228:231], v5 offset:38912
    v_mfma_f32_16x16x32_bf16 v[152:155], a[76:79], a[200:203], v[152:155]
    ds_read_b64_tr_b16 a[90:91], v62 offset:13824
    v_cndmask_b32 v27, v221, 0, vcc
    v_mfma_f32_16x16x32_bf16 v[160:163], a[72:75], a[204:207], v[160:163]
    ds_read_b128 a[232:235], v5 offset:55296
    v_cmp_le_i32 vcc, 7, v220
    v_mfma_f32_16x16x32_bf16 v[164:167], a[76:79], a[204:207], v[164:167]
    ds_read_b64_tr_b16 a[92:93], v62 offset:14336
    v_add_u32 v222, 9, v220
    v_mfma_f32_16x16x32_bf16 v[172:175], a[72:75], a[208:211], v[172:175]
    buffer_load_dwordx4 v72, s[8:11], s3 offen offset:1024 lds
    ds_read_b128 a[236:239], v65 offset:6144
    v_mfma_f32_16x16x32_bf16 v[176:179], a[76:79], a[208:211], v[176:179]
    ds_read_b64_tr_b16 a[94:95], v62 offset:14848
    v_cndmask_b32 v24, v221, 0, vcc
    v_mfma_f32_16x16x32_bf16 v[132:135], a[192:195], a[80:83], v[132:135]
    v_cmp_ge_u32 vcc, 7, v222
    v_or_b32 v32, s88, v24
    v_mfma_f32_16x16x32_bf16 v[144:147], a[196:199], a[80:83], v[144:147]
    buffer_load_dwordx4 v72, s[8:11], s3 offen offset:2048 lds
    v_cndmask_b32 v28, v221, 0, vcc
    v_mfma_f32_16x16x32_bf16 v[156:159], a[200:203], a[80:83], v[156:159]
    v_cmp_le_i32 vcc, 6, v220
    v_add_u32 v222, 10, v220
    v_mfma_f32_16x16x32_bf16 v[168:171], a[204:207], a[80:83], v[168:171]
    v_cndmask_b32 v25, v221, 0, vcc
    v_cmp_ge_u32 vcc, 7, v222
    v_mfma_f32_16x16x32_bf16 v[180:183], a[208:211], a[80:83], v[180:183]
    s_waitcnt vmcnt(14) lgkmcnt(0)
    s_barrier
    v_mfma_f32_16x16x32_bf16 v[184:187], a[236:239], a[236:239], v[184:187]
    s_add_u32 m0, s79, 12288
    s_lshr_b32 s3, s62, 4
    v_mfma_f32_16x16x32_bf16 v[188:191], v[36:39], a[236:239], v[188:191]
    buffer_load_dwordx4 v58, s[4:7], s3 offen  lds
    ds_read_b128 a[192:195], v6 offset:4096
    v_mfma_f32_16x16x32_bf16 v[192:195], a[216:219], a[216:219], v[192:195]
    ds_read_b64_tr_b16 a[96:97], v62 offset:24576
    ds_read_b128 a[196:199], v4 offset:8192
    v_mfma_f32_16x16x32_bf16 v[124:127], a[84:87], a[216:219], v[124:127]
    ds_read_b64_tr_b16 a[98:99], v62 offset:25088
    v_or_b32 v33, s88, v25
    v_mfma_f32_16x16x32_bf16 v[128:131], a[88:91], a[216:219], v[128:131]
    buffer_load_dwordx4 v59, s[4:7], s3 offen offset:1024  lds
    ds_read_b128 a[200:203], v4 offset:24576
    v_mfma_f32_16x16x32_bf16 v[136:139], a[84:87], a[220:223], v[136:139]
    ds_read_b64_tr_b16 a[100:101], v62 offset:25600
    v_cndmask_b32 v29, v221, 0, vcc
    v_mfma_f32_16x16x32_bf16 v[140:143], a[88:91], a[220:223], v[140:143]
    s_add_u32 m0, s81, 73728
    s_mul_i32 s3, s62, 96
    v_mfma_f32_16x16x32_bf16 v[148:151], a[84:87], a[224:227], v[148:151]
    buffer_load_dwordx4 v60, s[8:11], s3 offen offset:0 lds
    ds_read_b128 a[204:207], v4 offset:40960
    v_mfma_f32_16x16x32_bf16 v[152:155], a[88:91], a[224:227], v[152:155]
    ds_read_b64_tr_b16 a[102:103], v62 offset:26112
    v_mov_b32 v220, 0x0B0B0909
    v_mfma_f32_16x16x32_bf16 v[160:163], a[84:87], a[228:231], v[160:163]
    ds_read_b128 a[208:211], v4 offset:57344
    v_perm_b32 v222, v23, v22, v220
    v_mfma_f32_16x16x32_bf16 v[164:167], a[88:91], a[228:231], v[164:167]
    ds_read_b64_tr_b16 a[104:105], v62 offset:26624
    v_not_b32 v34, v222
    v_mfma_f32_16x16x32_bf16 v[172:175], a[84:87], a[232:235], v[172:175]
    buffer_load_dwordx4 v60, s[8:11], s3 offen offset:1024 lds
    ds_read_b128 a[212:215], v64 offset:8192
    v_mfma_f32_16x16x32_bf16 v[176:179], a[88:91], a[232:235], v[176:179]
    ds_read_b64_tr_b16 a[106:107], v62 offset:27136
    v_perm_b32 v222, v25, v24, v220
    v_mfma_f32_16x16x32_bf16 v[132:135], a[216:219], a[92:95], v[132:135]
    v_not_b32 v35, v222
    v_mov_b32 v20, 1.0
    v_mfma_f32_16x16x32_bf16 v[144:147], a[220:223], a[92:95], v[144:147]
    buffer_load_dwordx4 v60, s[8:11], s3 offen offset:2048 lds
    v_mov_b32 v21, 0
    v_mfma_f32_16x16x32_bf16 v[156:159], a[224:227], a[92:95], v[156:159]
    v_mov_b32 v220, 0
    v_mfma_f32_16x16x32_bf16 v[168:171], a[228:231], a[92:95], v[168:171]
    v_dot2c_f32_bf16 v220, v208, v36
    v_mfma_f32_16x16x32_bf16 v[180:183], a[232:235], a[92:95], v[180:183]
    s_waitcnt vmcnt(15) lgkmcnt(0)
    s_barrier
    v_mfma_f32_16x16x32_bf16 v[184:187], a[212:215], a[212:215], v[184:187]
    s_add_u32 m0, s81, 86016
    s_mul_i32 s3, s62, 96
    v_mfma_f32_16x16x32_bf16 v[188:191], v[36:39], a[212:215], v[188:191]
    buffer_load_dwordx4 v72, s[8:11], s3 offen offset:0 lds
    ds_read_b128 a[216:219], v7 offset:4096
    v_mfma_f32_16x16x32_bf16 v[192:195], a[192:195], a[192:195], v[192:195]
    ds_read_b64_tr_b16 a[108:109], v62 offset:36864
    v_mfma_f32_16x16x32_bf16 v[124:127], a[96:99], a[192:195], v[124:127]
    ds_read_b128 a[220:223], v5 offset:8192
    v_mfma_f32_16x16x32_bf16 v[128:131], a[100:103], a[192:195], v[128:131]
    buffer_load_dwordx4 v72, s[8:11], s3 offen offset:1024 lds
    ds_read_b64_tr_b16 a[110:111], v62 offset:37376
    v_mfma_f32_16x16x32_bf16 v[136:139], a[96:99], a[196:199], v[136:139]
    ds_read_b128 a[224:227], v5 offset:24576
    v_mfma_f32_16x16x32_bf16 v[140:143], a[100:103], a[196:199], v[140:143]
    ds_read_b64_tr_b16 a[112:113], v62 offset:37888
    v_mfma_f32_16x16x32_bf16 v[148:151], a[96:99], a[200:203], v[148:151]
    buffer_load_dwordx4 v72, s[8:11], s3 offen offset:2048 lds
    ds_read_b128 a[228:231], v5 offset:40960
    v_mfma_f32_16x16x32_bf16 v[152:155], a[100:103], a[200:203], v[152:155]
    ds_read_b64_tr_b16 a[114:115], v62 offset:38400
    v_mfma_f32_16x16x32_bf16 v[160:163], a[96:99], a[204:207], v[160:163]
    ds_read_b128 a[232:235], v5 offset:57344
    v_mfma_f32_16x16x32_bf16 v[164:167], a[100:103], a[204:207], v[164:167]
    ds_read_b64_tr_b16 a[116:117], v62 offset:38912
    v_mfma_f32_16x16x32_bf16 v[172:175], a[96:99], a[208:211], v[172:175]
    buffer_load_dwordx4 v[86:89], v83, s[16:19], s92 offen sc1
    ds_read_b128 a[236:239], v65 offset:8192
    v_mfma_f32_16x16x32_bf16 v[176:179], a[100:103], a[208:211], v[176:179]
    ds_read_b64_tr_b16 a[118:119], v62 offset:39424
    v_mfma_f32_16x16x32_bf16 v[132:135], a[192:195], a[104:107], v[132:135]
    v_dot2c_f32_bf16 v220, v209, v36
    v_mfma_f32_16x16x32_bf16 v[144:147], a[196:199], a[104:107], v[144:147]
    buffer_load_dwordx4 v[90:93], v83, s[16:19], s93 offen sc1
    v_mfma_f32_16x16x32_bf16 v[156:159], a[200:203], a[104:107], v[156:159]
    v_dot2c_f32_bf16 v220, v210, v36
    v_mfma_f32_16x16x32_bf16 v[168:171], a[204:207], a[104:107], v[168:171]
    v_dot2c_f32_bf16 v220, v211, v36
    v_mfma_f32_16x16x32_bf16 v[180:183], a[208:211], a[104:107], v[180:183]
    s_waitcnt vmcnt(15) lgkmcnt(0)
    s_barrier
    v_mfma_f32_16x16x32_bf16 v[184:187], a[236:239], a[236:239], v[184:187]
    ds_read_b128 a[192:195], v6 offset:5120
    v_cndmask_b32 v50, v36, v50, s[72:73]
    v_mfma_f32_16x16x32_bf16 v[188:191], v[36:39], a[236:239], v[188:191]
    buffer_load_dwordx2 v[66:67], v69, s[16:19], s64 offen sc1
    ds_read_b64_tr_b16 a[120:121], v62 offset:49152
    v_mfma_f32_16x16x32_bf16 v[192:195], a[216:219], a[216:219], v[192:195]
    ds_read_b128 a[196:199], v4 offset:10240
    v_add_f32_dpp v220, v220, v220 row_ror:8 row_mask:0xf bank_mask:0xf
    v_mfma_f32_16x16x32_bf16 v[124:127], a[108:111], a[216:219], v[124:127]
    ds_read_b64_tr_b16 a[122:123], v62 offset:49664
    v_cndmask_b32 v50, v50, 0, s[74:75]
    v_mfma_f32_16x16x32_bf16 v[128:131], a[112:115], a[216:219], v[128:131]
    s_add_u32 m0, s81, 98304
    s_mul_i32 s3, s63, 96
    v_mfma_f32_16x16x32_bf16 v[136:139], a[108:111], a[220:223], v[136:139]
    buffer_load_dwordx4 v60, s[8:11], s3 offen offset:0 lds
    ds_read_b128 a[200:203], v4 offset:26624
    v_mfma_f32_16x16x32_bf16 v[140:143], a[112:115], a[220:223], v[140:143]
    ds_read_b64_tr_b16 a[124:125], v62 offset:50176
    v_add_f32_dpp v220, v220, v220 row_ror:4 row_mask:0xf bank_mask:0xf
    v_mfma_f32_16x16x32_bf16 v[148:151], a[108:111], a[224:227], v[148:151]
    ds_read_b128 a[204:207], v4 offset:43008
    v_cndmask_b32 v51, v36, v51, s[72:73]
    v_mfma_f32_16x16x32_bf16 v[152:155], a[112:115], a[224:227], v[152:155]
    ds_read_b64_tr_b16 a[126:127], v62 offset:50688
    v_add_f32_dpp v220, v220, v220 row_ror:2 row_mask:0xf bank_mask:0xf
    v_mfma_f32_16x16x32_bf16 v[160:163], a[108:111], a[228:231], v[160:163]
    buffer_load_dwordx4 v60, s[8:11], s3 offen offset:1024 lds
    ds_read_b128 a[208:211], v4 offset:59392
    v_mfma_f32_16x16x32_bf16 v[164:167], a[112:115], a[228:231], v[164:167]
    ds_read_b64_tr_b16 a[128:129], v62 offset:51200
    v_cndmask_b32 v51, v51, 0, s[74:75]
    v_mfma_f32_16x16x32_bf16 v[172:175], a[108:111], a[232:235], v[172:175]
    ds_read_b128 a[212:215], v64 offset:10240
    v_add_f32_dpp v220, v220, v220 row_ror:1 row_mask:0xf bank_mask:0xf
    v_mfma_f32_16x16x32_bf16 v[176:179], a[112:115], a[232:235], v[176:179]
    ds_read_b64_tr_b16 a[130:131], v62 offset:51712
    v_cndmask_b32 v52, v36, v52, s[72:73]
    v_mfma_f32_16x16x32_bf16 v[132:135], a[216:219], a[116:119], v[132:135]
    buffer_load_dwordx4 v60, s[8:11], s3 offen offset:2048 lds
    v_mov_b32 v221, v220
    v_mfma_f32_16x16x32_bf16 v[144:147], a[220:223], a[116:119], v[144:147]
    v_cndmask_b32 v52, v52, 0, s[74:75]
    v_permlane32_swap_b32 v220, v221
    v_mfma_f32_16x16x32_bf16 v[156:159], a[224:227], a[116:119], v[156:159]
    v_cndmask_b32 v53, v36, v53, s[72:73]
    v_add_f32 v220, v220, v221
    v_mfma_f32_16x16x32_bf16 v[168:171], a[228:231], a[116:119], v[168:171]
    v_cndmask_b32 v53, v53, 0, s[74:75]
    v_mov_b32 v221, v220
    v_mfma_f32_16x16x32_bf16 v[180:183], a[232:235], a[116:119], v[180:183]
    s_waitcnt vmcnt(14) lgkmcnt(0)
    s_barrier
    s_add_u32 m0, s81, 110592
    s_mul_i32 s3, s63, 96
    v_mfma_f32_16x16x32_bf16 v[184:187], a[212:215], a[212:215], v[184:187]
    buffer_load_dwordx4 v72, s[8:11], s3 offen offset:0 lds
    ds_read_b128 a[216:219], v7 offset:5120
    v_mfma_f32_16x16x32_bf16 v[188:191], v[36:39], a[212:215], v[188:191]
    buffer_load_dwordx4 v72, s[8:11], s3 offen offset:1024 lds
    ds_read_b64_tr_b16 a[132:133], v62 offset:61440
    v_mfma_f32_16x16x32_bf16 v[192:195], a[192:195], a[192:195], v[192:195]
    ds_read_b128 a[220:223], v5 offset:10240
    ds_read_b64_tr_b16 a[134:135], v62 offset:61952
    v_mfma_f32_16x16x32_bf16 v[124:127], a[120:123], a[192:195], v[124:127]
    buffer_load_dwordx4 v72, s[8:11], s3 offen offset:2048 lds
    ds_read_b128 a[224:227], v5 offset:26624
    v_mfma_f32_16x16x32_bf16 v[128:131], a[124:127], a[192:195], v[128:131]
    s_add_u32 m0, s86, 122880
    s_lshl_b32 s3, s62, 5
    v_mfma_f32_16x16x32_bf16 v[136:139], a[120:123], a[196:199], v[136:139]
    buffer_load_dwordx4 v61, s[12:15], s3 offen lds
    ds_read_b64_tr_b16 a[136:137], v62 offset:62464
    v_mfma_f32_16x16x32_bf16 v[140:143], a[124:127], a[196:199], v[140:143]
    s_add_u32 m0, s86, 126976
    s_lshl_b32 s3, s62, 5
    v_mfma_f32_16x16x32_bf16 v[148:151], a[120:123], a[200:203], v[148:151]
    buffer_load_dwordx4 v73, s[12:15], s3 offen lds
    ds_read_b128 a[228:231], v5 offset:43008
    v_mfma_f32_16x16x32_bf16 v[152:155], a[124:127], a[200:203], v[152:155]
    s_add_u32 m0, s86, 131072
    s_lshl_b32 s3, s63, 5
    v_mfma_f32_16x16x32_bf16 v[160:163], a[120:123], a[204:207], v[160:163]
    buffer_load_dwordx4 v61, s[12:15], s3 offen lds
    ds_read_b64_tr_b16 a[138:139], v62 offset:62976
    v_mfma_f32_16x16x32_bf16 v[164:167], a[124:127], a[204:207], v[164:167]
    ds_read_b128 a[232:235], v5 offset:59392
    ds_read_b64_tr_b16 a[140:141], v62 offset:63488
    v_mfma_f32_16x16x32_bf16 v[172:175], a[120:123], a[208:211], v[172:175]
    buffer_load_dword v70, v12, s[40:43], 0 offen
    ds_read_b128 a[236:239], v65 offset:10240
    v_mfma_f32_16x16x32_bf16 v[176:179], a[124:127], a[208:211], v[176:179]
    ds_read_b64_tr_b16 a[142:143], v62 offset:64000
    v_cndmask_b32 v54, v36, v54, s[72:73]
    v_mfma_f32_16x16x32_bf16 v[132:135], a[192:195], a[128:131], v[132:135]
    buffer_load_dword v70, v12, s[40:43], s84 offen
    v_permlane16_swap_b32 v220, v221
    v_mfma_f32_16x16x32_bf16 v[144:147], a[196:199], a[128:131], v[144:147]
    v_cndmask_b32 v54, v54, 0, s[74:75]
    v_add_f32 v220, v220, v221
    v_mfma_f32_16x16x32_bf16 v[156:159], a[200:203], a[128:131], v[156:159]
    buffer_load_dword v70, v74, s[36:39], 0 offen
    v_cndmask_b32 v55, v36, v55, s[72:73]
    v_mfma_f32_16x16x32_bf16 v[168:171], a[204:207], a[128:131], v[168:171]
    v_readfirstlane_b32 s54, v220
    v_cndmask_b32 v55, v55, 0, s[74:75]
    v_mfma_f32_16x16x32_bf16 v[180:183], a[208:211], a[128:131], v[180:183]
    s_waitcnt vmcnt(18) lgkmcnt(0)
    s_barrier
    v_mfma_f32_16x16x32_bf16 v[184:187], a[236:239], a[236:239], v[184:187]
    s_add_u32 m0, s86, 135168
    s_lshl_b32 s3, s63, 5
    v_mfma_f32_16x16x32_bf16 v[188:191], v[36:39], a[236:239], v[188:191]
    buffer_load_dwordx4 v73, s[12:15], s3 offen lds
    ds_read_b128 a[192:195], v6 offset:6144
    v_mfma_f32_16x16x32_bf16 v[192:195], a[216:219], a[216:219], v[192:195]
    ds_read_b64_tr_b16 a[144:145], v62 offset:0
    ds_read_b128 a[196:199], v4 offset:12288
    v_mfma_f32_16x16x32_bf16 v[124:127], a[132:135], a[216:219], v[124:127]
    ds_read_b64_tr_b16 a[146:147], v62 offset:512
    ds_read_b128 a[200:203], v4 offset:28672
    v_mfma_f32_16x16x32_bf16 v[128:131], a[136:139], a[216:219], v[128:131]
    ds_read_b64_tr_b16 a[148:149], v62 offset:1024
    v_cndmask_b32 v56, v36, v56, s[72:73]
    v_mfma_f32_16x16x32_bf16 v[136:139], a[132:135], a[220:223], v[136:139]
    ds_read_b128 a[204:207], v4 offset:45056
    v_cndmask_b32 v56, v56, 0, s[74:75]
    v_mfma_f32_16x16x32_bf16 v[140:143], a[136:139], a[220:223], v[140:143]
    buffer_load_dword v70, v14, s[40:43], 0 offen
    ds_read_b64_tr_b16 a[150:151], v62 offset:1536
    v_mfma_f32_16x16x32_bf16 v[148:151], a[132:135], a[224:227], v[148:151]
    ds_read_b128 a[208:211], v4 offset:61440
    v_cndmask_b32 v57, v36, v57, s[72:73]
    v_mfma_f32_16x16x32_bf16 v[152:155], a[136:139], a[224:227], v[152:155]
    ds_read_b64_tr_b16 a[152:153], v62 offset:2048
    v_cndmask_b32 v57, v57, 0, s[74:75]
    v_mfma_f32_16x16x32_bf16 v[160:163], a[132:135], a[228:231], v[160:163]
    ds_read_b128 a[212:215], v64 offset:12288
    v_mfma_f32_16x16x32_bf16 v[164:167], a[136:139], a[228:231], v[164:167]
    ds_read_b64_tr_b16 a[154:155], v62 offset:2560
    v_mfma_f32_16x16x32_bf16 v[172:175], a[132:135], a[232:235], v[172:175]
    ds_read_b128 a[240:243], v64 offset:14336
    v_mfma_f32_16x16x32_bf16 v[176:179], a[136:139], a[232:235], v[176:179]
    buffer_load_dword v70, v14, s[40:43], 0 offen offset:1024
    ds_read_b128 a[244:247], v6 offset:7168
    v_mfma_f32_16x16x32_bf16 v[132:135], a[216:219], a[140:143], v[132:135]
    v_mfma_f32_16x16x32_bf16 v[144:147], a[220:223], a[140:143], v[144:147]
    v_mfma_f32_16x16x32_bf16 v[156:159], a[224:227], a[140:143], v[156:159]
    v_mfma_f32_16x16x32_bf16 v[168:171], a[228:231], a[140:143], v[168:171]
    v_mfma_f32_16x16x32_bf16 v[180:183], a[232:235], a[140:143], v[180:183]
    s_waitcnt vmcnt(18) lgkmcnt(0)
    s_barrier
    v_mfma_f32_16x16x32_bf16 v[184:187], a[212:215], a[212:215], v[184:187]
    ds_read_b128 a[216:219], v7 offset:6144
    v_mfma_f32_16x16x32_bf16 v[188:191], v[36:39], a[212:215], v[188:191]
    buffer_load_dword v70, v82, s[40:43], 0 offen
    ds_read_b64_tr_b16 a[156:157], v62 offset:12288
    v_mfma_f32_16x16x32_bf16 v[192:195], a[192:195], a[192:195], v[192:195]
    ds_read_b128 a[220:223], v5 offset:12288
    v_mfma_f32_16x16x32_bf16 v[184:187], a[240:243], a[240:243], v[184:187]
    ds_read_b64_tr_b16 a[158:159], v62 offset:12800
    v_mfma_f32_16x16x32_bf16 v[188:191], v[36:39], a[240:243], v[188:191]
    ds_read_b128 a[224:227], v5 offset:28672
    v_mfma_f32_16x16x32_bf16 v[192:195], a[244:247], a[244:247], v[192:195]
    ds_read_b64_tr_b16 a[160:161], v62 offset:13312
    v_mfma_f32_16x16x32_bf16 v[124:127], a[144:147], a[192:195], v[124:127]
    ds_read_b128 a[228:231], v5 offset:45056
    v_mfma_f32_16x16x32_bf16 v[128:131], a[148:151], a[192:195], v[128:131]
    ds_read_b64_tr_b16 a[162:163], v62 offset:13824
    v_mfma_f32_16x16x32_bf16 v[136:139], a[144:147], a[196:199], v[136:139]
    ds_read_b128 a[232:235], v5 offset:61440
    v_mfma_f32_16x16x32_bf16 v[140:143], a[148:151], a[196:199], v[140:143]
    ds_read_b64_tr_b16 a[164:165], v62 offset:14336
    v_mfma_f32_16x16x32_bf16 v[148:151], a[144:147], a[200:203], v[148:151]
    ds_read_b128 a[236:239], v65 offset:12288
    v_mfma_f32_16x16x32_bf16 v[152:155], a[148:151], a[200:203], v[152:155]
    ds_read_b64_tr_b16 a[166:167], v62 offset:14848
    v_mfma_f32_16x16x32_bf16 v[160:163], a[144:147], a[204:207], v[160:163]
    ds_read_b128 a[248:251], v65 offset:14336
    v_mfma_f32_16x16x32_bf16 v[164:167], a[148:151], a[204:207], v[164:167]
    ds_read_b128 a[252:255], v7 offset:7168
    v_mfma_f32_16x16x32_bf16 v[172:175], a[144:147], a[208:211], v[172:175]
    v_mfma_f32_16x16x32_bf16 v[176:179], a[148:151], a[208:211], v[176:179]
    v_mfma_f32_16x16x32_bf16 v[132:135], a[192:195], a[152:155], v[132:135]
    v_mfma_f32_16x16x32_bf16 v[144:147], a[196:199], a[152:155], v[144:147]
    v_mfma_f32_16x16x32_bf16 v[156:159], a[200:203], a[152:155], v[156:159]
    v_mfma_f32_16x16x32_bf16 v[168:171], a[204:207], a[152:155], v[168:171]
    v_mfma_f32_16x16x32_bf16 v[180:183], a[208:211], a[152:155], v[180:183]
    s_waitcnt vmcnt(13) lgkmcnt(0)
    s_barrier
    v_mfma_f32_16x16x32_bf16 v[184:187], a[236:239], a[236:239], v[184:187]
    ds_read_b128 a[192:195], v6 offset:7168
    v_min3_u32 v86, v86, v87, v88
    v_mfma_f32_16x16x32_bf16 v[188:191], v[36:39], a[236:239], v[188:191]
    ds_read_b64_tr_b16 a[168:169], v62 offset:24576
    v_min3_u32 v89, v89, v90, v91
    v_mfma_f32_16x16x32_bf16 v[192:195], a[216:219], a[216:219], v[192:195]
    ds_read_b128 a[196:199], v4 offset:14336
    v_min3_u32 v86, v86, v92, v93
    v_mfma_f32_16x16x32_bf16 v[184:187], a[248:251], a[248:251], v[184:187]
    ds_read_b64_tr_b16 a[170:171], v62 offset:25088
    v_min_u32 v86, v86, v89
    v_mfma_f32_16x16x32_bf16 v[188:191], v[36:39], a[248:251], v[188:191]
    ds_read_b128 a[200:203], v4 offset:30720
    v_cmp_ne_u32 vcc, -1, v86
    v_mfma_f32_16x16x32_bf16 v[192:195], a[252:255], a[252:255], v[192:195]
    ds_read_b64_tr_b16 a[172:173], v62 offset:25600
    s_or_b32 s89, vcc_lo, vcc_hi
    v_mfma_f32_16x16x32_bf16 v[124:127], a[156:159], a[216:219], v[124:127]
    ds_read_b128 a[204:207], v4 offset:47104
    v_mfma_f32_16x16x32_bf16 v[128:131], a[160:163], a[216:219], v[128:131]
    ds_read_b64_tr_b16 a[174:175], v62 offset:26112
    v_mfma_f32_16x16x32_bf16 v[136:139], a[156:159], a[220:223], v[136:139]
    ds_read_b128 a[208:211], v4 offset:63488
    v_mfma_f32_16x16x32_bf16 v[140:143], a[160:163], a[220:223], v[140:143]
    ds_read_b64_tr_b16 a[176:177], v62 offset:26624
    v_mfma_f32_16x16x32_bf16 v[148:151], a[156:159], a[224:227], v[148:151]
    ds_read_b64_tr_b16 a[178:179], v62 offset:27136
    v_mfma_f32_16x16x32_bf16 v[152:155], a[160:163], a[224:227], v[152:155]
    v_mfma_f32_16x16x32_bf16 v[160:163], a[156:159], a[228:231], v[160:163]
    v_mfma_f32_16x16x32_bf16 v[164:167], a[160:163], a[228:231], v[164:167]
    v_mfma_f32_16x16x32_bf16 v[172:175], a[156:159], a[232:235], v[172:175]
    v_mfma_f32_16x16x32_bf16 v[176:179], a[160:163], a[232:235], v[176:179]
    v_mfma_f32_16x16x32_bf16 v[132:135], a[216:219], a[164:167], v[132:135]
    v_mfma_f32_16x16x32_bf16 v[144:147], a[220:223], a[164:167], v[144:147]
    v_mfma_f32_16x16x32_bf16 v[156:159], a[224:227], a[164:167], v[156:159]
    v_mfma_f32_16x16x32_bf16 v[168:171], a[228:231], a[164:167], v[168:171]
    v_mfma_f32_16x16x32_bf16 v[180:183], a[232:235], a[164:167], v[180:183]
    s_waitcnt vmcnt(10) lgkmcnt(0)
    s_barrier
    v_mfma_f32_16x16x32_bf16 v[124:127], a[168:171], a[192:195], v[124:127]
    ds_read_b128 a[216:219], v7 offset:7168
    ds_read_b64_tr_b16 a[180:181], v62 offset:36864
    v_mfma_f32_16x16x32_bf16 v[128:131], a[172:175], a[192:195], v[128:131]
    ds_read_b128 a[220:223], v5 offset:14336
    v_mov_b32 v196, v192
    v_mfma_f32_16x16x32_bf16 v[136:139], a[168:171], a[196:199], v[136:139]
    ds_read_b64_tr_b16 a[182:183], v62 offset:37376
    v_mov_b32 v197, v192
    v_mfma_f32_16x16x32_bf16 v[140:143], a[172:175], a[196:199], v[140:143]
    ds_read_b128 a[224:227], v5 offset:30720
    v_cndmask_b32 v184, v184, v185, s[72:73]
    v_mfma_f32_16x16x32_bf16 v[148:151], a[168:171], a[200:203], v[148:151]
    ds_read_b64_tr_b16 a[184:185], v62 offset:37888
    v_cndmask_b32 v186, v186, v187, s[72:73]
    v_mfma_f32_16x16x32_bf16 v[152:155], a[172:175], a[200:203], v[152:155]
    ds_read_b128 a[228:231], v5 offset:47104
    v_cndmask_b32 v198, v184, v186, s[74:75]
    v_mfma_f32_16x16x32_bf16 v[160:163], a[168:171], a[204:207], v[160:163]
    ds_read_b64_tr_b16 a[186:187], v62 offset:38400
    v_permlane32_swap_b32 v196, v197
    v_mfma_f32_16x16x32_bf16 v[164:167], a[172:175], a[204:207], v[164:167]
    ds_read_b128 a[232:235], v5 offset:63488
    v_cndmask_b32 v192, v192, v193, s[72:73]
    v_mfma_f32_16x16x32_bf16 v[172:175], a[168:171], a[208:211], v[172:175]
    ds_read_b64_tr_b16 a[188:189], v62 offset:38912
    v_cndmask_b32 v194, v194, v195, s[72:73]
    v_mfma_f32_16x16x32_bf16 v[176:179], a[172:175], a[208:211], v[176:179]
    ds_read_b64_tr_b16 a[190:191], v62 offset:39424
    v_cndmask_b32 v199, v192, v194, s[74:75]
    v_mfma_f32_16x16x32_bf16 v[132:135], a[192:195], a[176:179], v[132:135]
    v_mul_f32 v200, 0xBB000000, v188
    v_mul_f32 v202, 0xBB000000, v196
    v_mfma_f32_16x16x32_bf16 v[144:147], a[196:199], a[176:179], v[144:147]
    v_mul_f32 v198, 0x3B000000, v198
    v_mul_f32 v199, 0x3B000000, v199
    v_mfma_f32_16x16x32_bf16 v[156:159], a[200:203], a[176:179], v[156:159]
    v_fma_f32 v198, -v200, v200, v198
    v_fma_f32 v199, -v202, v202, v199
    v_mfma_f32_16x16x32_bf16 v[168:171], a[204:207], a[176:179], v[168:171]
    v_max_f32 v198, 0, v198
    v_max_f32 v199, 0, v199
    v_mfma_f32_16x16x32_bf16 v[180:183], a[208:211], a[176:179], v[180:183]
    v_add_f32 v198, 925353388, v198
    v_add_f32 v199, 925353388, v199
    v_rsq_f32 v201, v198
    v_rsq_f32 v203, v199
    v_cmp_eq_u32 vcc, s49, v66
    ds_write2_b32 v76, v200, v201 offset0:16 offset1:96
    ds_write2_b32 v77, v202, v203 offset0:0 offset1:80
    v_cmp_eq_u32 s[70:71], s50, v67
    s_and_b32 s64, vcc_lo, s70
    s_cmp_eq_u32 s64, -1
    s_cselect_b32 s50, 1, 0
    s_waitcnt lgkmcnt(0)
    s_barrier
    v_mfma_f32_16x16x32_bf16 v[124:127], a[180:183], a[216:219], v[124:127]
    ds_read2_b32 v[196:197], v17 offset0:0 offset1:80
    ds_read_b128 v[198:201], v18 offset:0
    v_mfma_f32_16x16x32_bf16 v[128:131], a[184:187], a[216:219], v[128:131]
    ds_read_b128 v[202:205], v18 offset:320
    ds_read2_b32 v[206:207], v17 offset0:16 offset1:96
    v_mfma_f32_16x16x32_bf16 v[136:139], a[180:183], a[220:223], v[136:139]
    ds_read_b128 v[208:211], v18 offset:64
    ds_read_b128 v[212:215], v18 offset:384
    v_mfma_f32_16x16x32_bf16 v[140:143], a[184:187], a[220:223], v[140:143]
    ds_read2_b32 v[216:217], v17 offset0:32 offset1:112
    ds_read_b128 v[218:221], v18 offset:128
    v_mfma_f32_16x16x32_bf16 v[148:151], a[180:183], a[224:227], v[148:151]
    ds_read_b128 v[222:225], v18 offset:448
    ds_read2_b32 v[226:227], v17 offset0:48 offset1:128
    v_mfma_f32_16x16x32_bf16 v[152:155], a[184:187], a[224:227], v[152:155]
    ds_read_b128 v[228:231], v18 offset:192
    ds_read_b128 v[232:235], v18 offset:512
    v_mfma_f32_16x16x32_bf16 v[160:163], a[180:183], a[228:231], v[160:163]
    ds_read2_b32 v[236:237], v17 offset0:64 offset1:144
    ds_read_b128 v[238:241], v18 offset:256
    v_mfma_f32_16x16x32_bf16 v[164:167], a[184:187], a[228:231], v[164:167]
    ds_read_b128 v[242:245], v18 offset:576
    v_mov_b32_dpp v44, v128 row_newbcast:0 row_mask:0xf bank_mask:0xf
    v_mfma_f32_16x16x32_bf16 v[172:175], a[180:183], a[232:235], v[172:175]
    v_mov_b32_dpp v40, v124 row_newbcast:0 row_mask:0xf bank_mask:0xf
    v_mov_b32_dpp v45, v129 row_newbcast:0 row_mask:0xf bank_mask:0xf
    v_mfma_f32_16x16x32_bf16 v[176:179], a[184:187], a[232:235], v[176:179]
    v_mov_b32_dpp v41, v125 row_newbcast:0 row_mask:0xf bank_mask:0xf
    v_mov_b32_dpp v46, v130 row_newbcast:0 row_mask:0xf bank_mask:0xf
    v_mfma_f32_16x16x32_bf16 v[132:135], a[216:219], a[188:191], v[132:135]
    v_mov_b32_dpp v42, v126 row_newbcast:0 row_mask:0xf bank_mask:0xf
    v_mov_b32_dpp v47, v131 row_newbcast:0 row_mask:0xf bank_mask:0xf
    v_mfma_f32_16x16x32_bf16 v[144:147], a[220:223], a[188:191], v[144:147]
    v_mov_b32_dpp v43, v127 row_newbcast:0 row_mask:0xf bank_mask:0xf
    v_mfma_f32_16x16x32_bf16 v[156:159], a[224:227], a[188:191], v[156:159]
    v_mfma_f32_16x16x32_bf16 v[168:171], a[228:231], a[188:191], v[168:171]
    v_mfma_f32_16x16x32_bf16 v[180:183], a[232:235], a[188:191], v[180:183]
    s_waitcnt lgkmcnt(14)
    v_pk_fma_f32 v[128:129], v[44:45], v[196:197], v[128:129] op_sel_hi:[1,0,1]
    v_pk_fma_f32 v[130:131], v[46:47], v[196:197], v[130:131] op_sel_hi:[1,0,1]
    v_pk_mul_f32 v[128:129], v[128:129], v[196:197] op_sel:[0,1] op_sel_hi:[1,1]
    v_pk_mul_f32 v[130:131], v[130:131], v[196:197] op_sel:[0,1] op_sel_hi:[1,1]
    v_cvt_pk_bf16_f32 v128, v128, v129
    v_cvt_pk_bf16_f32 v129, v130, v131
    v_mov_b32 v48, v132
    v_mov_b32 v49, v132
    s_waitcnt lgkmcnt(11)
    v_pk_fma_f32 v[140:141], v[44:45], v[206:207], v[140:141] op_sel_hi:[1,0,1]
    v_pk_fma_f32 v[136:137], v[40:41], v[206:207], v[136:137] op_sel_hi:[1,0,1]
    v_pk_fma_f32 v[142:143], v[46:47], v[206:207], v[142:143] op_sel_hi:[1,0,1]
    s_add_u32 m0, s86, 73728
    s_lshl_b32 s3, s56, 5
    buffer_load_dwordx4 v61, s[12:15], s3 offen lds
    v_pk_fma_f32 v[138:139], v[42:43], v[206:207], v[138:139] op_sel_hi:[1,0,1]
    v_pk_mul_f32 v[140:141], v[140:141], v[206:207] op_sel:[0,1] op_sel_hi:[1,1]
    v_pk_mul_f32 v[142:143], v[142:143], v[206:207] op_sel:[0,1] op_sel_hi:[1,1]
    v_cvt_pk_bf16_f32 v136, v136, v137
    v_cvt_pk_bf16_f32 v140, v140, v141
    v_cvt_pk_bf16_f32 v137, v138, v139
    v_cvt_pk_bf16_f32 v141, v142, v143
    v_mul_f32 v138, 0x3EB8AA3B, v207
    v_permlane32_swap_b32 v48, v49
    s_waitcnt lgkmcnt(10)
    v_pk_fma_f32 v[144:145], v[208:209], v[48:49], v[144:145] op_sel_hi:[1,0,1]
    v_pk_fma_f32 v[146:147], v[210:211], v[48:49], v[146:147] op_sel_hi:[1,0,1]
    s_add_u32 m0, s86, 77824
    s_lshl_b32 s3, s56, 5
    buffer_load_dwordx4 v73, s[12:15], s3 offen lds
    s_waitcnt lgkmcnt(9)
    v_pk_mul_f32 v[144:145], v[144:145], v[212:213]
    v_pk_mul_f32 v[146:147], v[146:147], v[214:215]
    v_cvt_pk_bf16_f32 v186, v144, v145
    v_cvt_pk_bf16_f32 v187, v146, v147
    v_mfma_f32_16x16x16_bf16 v[208:211], v[128:129], v[136:137], v[30:33]
    v_mfma_f32_16x16x16_bf16 v[212:215], v[140:141], v[136:137], v[26:29]
    s_waitcnt lgkmcnt(8)
    v_pk_fma_f32 v[152:153], v[44:45], v[216:217], v[152:153] op_sel_hi:[1,0,1]
    v_pk_fma_f32 v[148:149], v[40:41], v[216:217], v[148:149] op_sel_hi:[1,0,1]
    v_pk_fma_f32 v[154:155], v[46:47], v[216:217], v[154:155] op_sel_hi:[1,0,1]
    v_pk_fma_f32 v[150:151], v[42:43], v[216:217], v[150:151] op_sel_hi:[1,0,1]
    v_pk_mul_f32 v[152:153], v[152:153], v[216:217] op_sel:[0,1] op_sel_hi:[1,1]
    s_add_u32 m0, s86, 81920
    s_lshl_b32 s3, s57, 5
    buffer_load_dwordx4 v61, s[12:15], s3 offen lds
    v_pk_mul_f32 v[154:155], v[154:155], v[216:217] op_sel:[0,1] op_sel_hi:[1,1]
    v_cvt_pk_bf16_f32 v148, v148, v149
    v_cvt_pk_bf16_f32 v152, v152, v153
    v_cvt_pk_bf16_f32 v149, v150, v151
    v_cvt_pk_bf16_f32 v153, v154, v155
    v_mul_f32 v150, 0x3EB8AA3B, v217
    s_waitcnt lgkmcnt(7)
    v_pk_fma_f32 v[156:157], v[218:219], v[48:49], v[156:157] op_sel_hi:[1,0,1]
    v_pk_fma_f32 v[158:159], v[220:221], v[48:49], v[158:159] op_sel_hi:[1,0,1]
    s_waitcnt lgkmcnt(6)
    v_pk_mul_f32 v[156:157], v[156:157], v[222:223]
    v_pk_mul_f32 v[158:159], v[158:159], v[224:225]
    v_cvt_pk_bf16_f32 v188, v156, v157
    s_add_u32 m0, s86, 86016
    s_lshl_b32 s3, s57, 5
    buffer_load_dwordx4 v73, s[12:15], s3 offen lds
    v_cvt_pk_bf16_f32 v189, v158, v159
    v_mfma_f32_16x16x16_bf16 v[218:221], v[140:141], v[148:149], v[22:25]
    v_mfma_f32_16x16x16_bf16 v[222:225], v[152:153], v[148:149], v[26:29]
    s_waitcnt lgkmcnt(5)
    v_pk_fma_f32 v[164:165], v[44:45], v[226:227], v[164:165] op_sel_hi:[1,0,1]
    v_pk_fma_f32 v[160:161], v[40:41], v[226:227], v[160:161] op_sel_hi:[1,0,1]
    v_pk_fma_f32 v[166:167], v[46:47], v[226:227], v[166:167] op_sel_hi:[1,0,1]
    v_pk_fma_f32 v[162:163], v[42:43], v[226:227], v[162:163] op_sel_hi:[1,0,1]
    v_pk_mul_f32 v[164:165], v[164:165], v[226:227] op_sel:[0,1] op_sel_hi:[1,1]
    v_pk_mul_f32 v[166:167], v[166:167], v[226:227] op_sel:[0,1] op_sel_hi:[1,1]
    v_cvt_pk_bf16_f32 v160, v160, v161
    v_cvt_pk_bf16_f32 v164, v164, v165
    s_add_u32 m0, s86, 90112
    s_lshl_b32 s3, s58, 5
    buffer_load_dwordx4 v61, s[12:15], s3 offen lds
    v_cvt_pk_bf16_f32 v161, v162, v163
    v_cvt_pk_bf16_f32 v165, v166, v167
    v_mul_f32 v162, 0x3EB8AA3B, v227
    s_waitcnt lgkmcnt(4)
    v_pk_fma_f32 v[168:169], v[228:229], v[48:49], v[168:169] op_sel_hi:[1,0,1]
    v_pk_fma_f32 v[170:171], v[230:231], v[48:49], v[170:171] op_sel_hi:[1,0,1]
    s_waitcnt lgkmcnt(3)
    v_pk_mul_f32 v[168:169], v[168:169], v[232:233]
    v_pk_mul_f32 v[170:171], v[170:171], v[234:235]
    v_cvt_pk_bf16_f32 v190, v168, v169
    v_cvt_pk_bf16_f32 v191, v170, v171
    v_mfma_f32_16x16x16_bf16 v[228:231], v[152:153], v[160:161], v[22:25]
    v_mfma_f32_16x16x16_bf16 v[232:235], v[164:165], v[160:161], v[26:29]
    s_add_u32 m0, s86, 94208
    s_lshl_b32 s3, s58, 5
    buffer_load_dwordx4 v73, s[12:15], s3 offen lds
    s_waitcnt lgkmcnt(2)
    v_pk_fma_f32 v[176:177], v[44:45], v[236:237], v[176:177] op_sel_hi:[1,0,1]
    v_pk_fma_f32 v[172:173], v[40:41], v[236:237], v[172:173] op_sel_hi:[1,0,1]
    v_pk_fma_f32 v[178:179], v[46:47], v[236:237], v[178:179] op_sel_hi:[1,0,1]
    v_pk_fma_f32 v[174:175], v[42:43], v[236:237], v[174:175] op_sel_hi:[1,0,1]
    v_pk_mul_f32 v[176:177], v[176:177], v[236:237] op_sel:[0,1] op_sel_hi:[1,1]
    v_pk_mul_f32 v[178:179], v[178:179], v[236:237] op_sel:[0,1] op_sel_hi:[1,1]
    v_cvt_pk_bf16_f32 v172, v172, v173
    v_cvt_pk_bf16_f32 v176, v176, v177
    v_cvt_pk_bf16_f32 v173, v174, v175
    v_cvt_pk_bf16_f32 v177, v178, v179
    v_mul_f32 v174, 0x3EB8AA3B, v237
    s_add_u32 m0, s86, 98304
    s_lshl_b32 s3, s59, 5
    buffer_load_dwordx4 v61, s[12:15], s3 offen lds
    s_waitcnt lgkmcnt(1)
    v_pk_fma_f32 v[180:181], v[238:239], v[48:49], v[180:181] op_sel_hi:[1,0,1]
    v_pk_fma_f32 v[182:183], v[240:241], v[48:49], v[182:183] op_sel_hi:[1,0,1]
    s_waitcnt lgkmcnt(0)
    v_pk_mul_f32 v[180:181], v[180:181], v[242:243]
    v_pk_mul_f32 v[182:183], v[182:183], v[244:245]
    v_cvt_pk_bf16_f32 v192, v180, v181
    v_cvt_pk_bf16_f32 v193, v182, v183
    v_mfma_f32_16x16x16_bf16 v[238:241], v[164:165], v[172:173], v[22:25]
    v_mfma_f32_16x16x16_bf16 v[242:245], v[176:177], v[172:173], v[26:29]
    v_pk_fma_f32 v[132:133], v[198:199], v[48:49], v[132:133] op_sel_hi:[1,0,1]
    v_pk_fma_f32 v[134:135], v[200:201], v[48:49], v[134:135] op_sel_hi:[1,0,1]
    v_pk_mul_f32 v[132:133], v[132:133], v[202:203]
    s_add_u32 m0, s86, 102400
    s_lshl_b32 s3, s59, 5
    buffer_load_dwordx4 v73, s[12:15], s3 offen lds
    v_pk_mul_f32 v[134:135], v[134:135], v[204:205]
    v_cvt_pk_bf16_f32 v184, v132, v133
    v_cvt_pk_bf16_f32 v185, v134, v135
    v_max_f32 v208, v208, v212
    v_max_f32 v209, v209, v213
    v_max_f32 v210, v210, v214
    v_max_f32 v211, v211, v215
    v_max3_f32 v206, v208, v209, v210
    v_max_f32 v206, v206, v211
    v_max_f32 v218, v218, v222
    v_max_f32 v219, v219, v223
    s_add_u32 m0, s86, 106496
    s_lshl_b32 s3, s60, 5
    buffer_load_dwordx4 v61, s[12:15], s3 offen lds
    v_max_f32 v220, v220, v224
    v_max_f32 v221, v221, v225
    v_max3_f32 v216, v218, v219, v220
    v_max_f32 v216, v216, v221
    v_max_f32 v228, v228, v232
    v_max_f32 v229, v229, v233
    v_max_f32 v230, v230, v234
    v_max_f32 v231, v231, v235
    v_max3_f32 v226, v228, v229, v230
    v_max_f32 v226, v226, v231
    v_max_f32 v238, v238, v242
    s_add_u32 m0, s86, 110592
    s_lshl_b32 s3, s60, 5
    buffer_load_dwordx4 v73, s[12:15], s3 offen lds
    v_max_f32 v239, v239, v243
    v_max_f32 v240, v240, v244
    v_max_f32 v241, v241, v245
    v_max3_f32 v236, v238, v239, v240
    v_max_f32 v236, v236, v241
    v_permlane32_swap_b32 v206, v216
    s_nop 0
    v_permlane32_swap_b32 v226, v236
    v_max_f32 v207, v206, v216
    v_max_f32 v227, v226, v236
    v_max_f32 v217, v206, v216
    v_max_f32 v237, v226, v236
    s_add_u32 m0, s86, 114688
    s_lshl_b32 s3, s61, 5
    buffer_load_dwordx4 v61, s[12:15], s3 offen lds
    v_permlane16_swap_b32 v207, v217
    v_permlane16_swap_b32 v227, v237
    v_max_f32 v206, v207, v217
    v_max_f32 v226, v227, v237
    v_max_f32 v216, v207, v217
    v_max_f32 v236, v227, v237
    s_nop 0
    v_permlane32_swap_b32 v206, v216
    v_permlane32_swap_b32 v226, v236
    v_mul_f32 v206, v206, v138
    v_mul_f32 v216, v216, v150
    v_pk_fma_f32 v[208:209], v[208:209], v[138:139], v[206:207] op_sel:[0,0,0] op_sel_hi:[1,0,0] neg_lo:[0,0,1] neg_hi:[0,0,1]
    s_add_u32 m0, s86, 118784
    s_lshl_b32 s3, s61, 5
    buffer_load_dwordx4 v73, s[12:15], s3 offen lds
    v_pk_fma_f32 v[218:219], v[218:219], v[150:151], v[216:217] op_sel:[0,0,0] op_sel_hi:[1,0,0] neg_lo:[0,0,1] neg_hi:[0,0,1]
    v_pk_fma_f32 v[210:211], v[210:211], v[138:139], v[206:207] op_sel:[0,0,0] op_sel_hi:[1,0,0] neg_lo:[0,0,1] neg_hi:[0,0,1]
    v_pk_fma_f32 v[220:221], v[220:221], v[150:151], v[216:217] op_sel:[0,0,0] op_sel_hi:[1,0,0] neg_lo:[0,0,1] neg_hi:[0,0,1]
    v_exp_f32 v208, v208
    v_exp_f32 v218, v218
    v_exp_f32 v209, v209
    v_exp_f32 v219, v219
    v_exp_f32 v210, v210
    v_exp_f32 v220, v220
    v_exp_f32 v211, v211
    v_exp_f32 v221, v221
    v_cvt_pk_bf16_f32 v206, v208, v209
    v_cvt_pk_bf16_f32 v216, v218, v219
    v_cvt_pk_bf16_f32 v207, v210, v211
    v_cvt_pk_bf16_f32 v217, v220, v221
    v_and_b32 v212, v34, v206
    v_and_b32 v222, v34, v216
    v_and_b32 v213, v35, v207
    v_and_b32 v223, v35, v217
    v_bfi_b32 v214, v34, 0, v206
    v_bfi_b32 v224, v34, 0, v216
    v_bfi_b32 v215, v35, 0, v207
    v_bfi_b32 v225, v35, 0, v217
    v_mul_f32 v226, v226, v162
    v_pk_fma_f32 v[228:229], v[228:229], v[162:163], v[226:227] op_sel:[0,0,0] op_sel_hi:[1,0,0] neg_lo:[0,0,1] neg_hi:[0,0,1]
    v_pk_fma_f32 v[230:231], v[230:231], v[162:163], v[226:227] op_sel:[0,0,0] op_sel_hi:[1,0,0] neg_lo:[0,0,1] neg_hi:[0,0,1]
    v_mfma_f32_16x16x16_bf16 v[140:143], v[36:37], v[206:207], 0
    v_mfma_f32_16x16x32_bf16 v[144:147], v[184:187], v[212:215], 0
    v_mfma_f32_16x16x16_bf16 v[152:155], v[36:37], v[216:217], 0
    v_mfma_f32_16x16x32_bf16 v[156:159], v[186:189], v[222:225], 0
    v_exp_f32 v228, v228
    v_mul_f32 v236, v236, v174
    v_exp_f32 v229, v229
    v_pk_fma_f32 v[238:239], v[238:239], v[174:175], v[236:237] op_sel:[0,0,0] op_sel_hi:[1,0,0] neg_lo:[0,0,1] neg_hi:[0,0,1]
    v_exp_f32 v230, v230
    v_pk_fma_f32 v[240:241], v[240:241], v[174:175], v[236:237] op_sel:[0,0,0] op_sel_hi:[1,0,0] neg_lo:[0,0,1] neg_hi:[0,0,1]
    v_exp_f32 v231, v231
    v_exp_f32 v238, v238
    v_cvt_pk_bf16_f32 v226, v228, v229
    v_exp_f32 v239, v239
    v_cvt_pk_bf16_f32 v227, v230, v231
    v_exp_f32 v240, v240
    v_and_b32 v232, v34, v226
    v_exp_f32 v241, v241
    v_and_b32 v233, v35, v227
    v_cvt_pk_bf16_f32 v236, v238, v239
    v_bfi_b32 v234, v34, 0, v226
    v_cvt_pk_bf16_f32 v237, v240, v241
    v_bfi_b32 v235, v35, 0, v227
    v_and_b32 v242, v34, v236
    v_and_b32 v243, v35, v237
    v_bfi_b32 v244, v34, 0, v236
    v_bfi_b32 v245, v35, 0, v237
    v_rcp_f32 v140, v140
    v_rcp_f32 v152, v152
    v_mfma_f32_16x16x16_bf16 v[164:167], v[36:37], v[226:227], 0
    v_mfma_f32_16x16x32_bf16 v[168:171], v[188:191], v[232:235], 0
    v_mfma_f32_16x16x16_bf16 v[176:179], v[36:37], v[236:237], 0
    v_mfma_f32_16x16x32_bf16 v[180:183], v[190:193], v[242:245], 0
    v_pk_mul_f32 v[144:145], v[144:145], v[140:141] op_sel_hi:[1,0]
    v_pk_mul_f32 v[156:157], v[156:157], v[152:153] op_sel_hi:[1,0]
    v_pk_mul_f32 v[146:147], v[146:147], v[140:141] op_sel_hi:[1,0]
    v_pk_mul_f32 v[158:159], v[158:159], v[152:153] op_sel_hi:[1,0]
    v_cvt_pk_bf16_f32 v124, v144, v145
    v_cvt_pk_bf16_f32 v126, v156, v157
    v_cvt_pk_bf16_f32 v125, v146, v147
    v_cvt_pk_bf16_f32 v127, v158, v159
    s_mov_b32 s65, 32768
    v_permlane16_swap_b32 v124, v126
    v_permlane16_swap_b32 v125, v127
    s_cmp_eq_u32 s50, 1
    s_cbranch_scc0 L_slow_1
    buffer_store_dwordx4 v[124:127], v12, s[40:43], 0 offen
L_join_2:
    v_rcp_f32 v164, v164
    v_rcp_f32 v176, v176
    v_pk_mul_f32 v[168:169], v[168:169], v[164:165] op_sel_hi:[1,0]
    v_pk_mul_f32 v[180:181], v[180:181], v[176:177] op_sel_hi:[1,0]
    v_pk_mul_f32 v[170:171], v[170:171], v[164:165] op_sel_hi:[1,0]
    v_pk_mul_f32 v[182:183], v[182:183], v[176:177] op_sel_hi:[1,0]
    v_cvt_pk_bf16_f32 v128, v168, v169
    v_cvt_pk_bf16_f32 v130, v180, v181
    v_cvt_pk_bf16_f32 v129, v170, v171
    v_cvt_pk_bf16_f32 v131, v182, v183
    v_permlane16_swap_b32 v128, v130
    s_nop 0
    v_permlane16_swap_b32 v129, v131
    s_cmp_eq_u32 s50, 1
    s_cbranch_scc0 L_slow_3
    buffer_store_dwordx4 v[128:131], v12, s[40:43], s65 offen
L_join_4:
L_oh:
    ds_read_b64 v[196:197], v248
    ds_read_b64 v[198:199], v249
    ds_read_b64 v[200:201], v250
    ds_read_b64 v[202:203], v251
    s_mov_b32 s64, 73728
    s_lshl_b32 s65, s45, 7
    s_lshl_b32 s66, s47, 2
    s_add_u32 s65, s65, s66
    v_mov_b32 v204, s65
    s_mul_i32 s66, s55, 3
    s_add_u32 s66, s66, s49
    s_add_u32 s66, s66, 1
    v_mov_b32 v205, s66
    v_bfe_u32 v206, v0, 2, 3
    v_and_b32 v207, 3, v0
    v_lshlrev_b32 v207, 2, v207
    v_lshl_add_u32 v206, v206, 7, v207
    s_waitcnt vmcnt(2) lgkmcnt(0)
    s_barrier
    ds_read_b64_tr_b16 v[124:125], v8 offset:0
    ds_read_b64_tr_b16 v[126:127], v8 offset:512
    ds_read_b64_tr_b16 v[128:129], v9 offset:0
    ds_read_b64_tr_b16 v[130:131], v9 offset:512
    ds_read_b64_tr_b16 v[132:133], v10 offset:0
    ds_read_b64_tr_b16 v[134:135], v10 offset:512
    ds_read_b64_tr_b16 v[136:137], v11 offset:0
    ds_read_b64_tr_b16 v[138:139], v11 offset:512
    ds_read_b64_tr_b16 v[140:141], v8 offset:4096
    ds_read_b64_tr_b16 v[142:143], v8 offset:4608
    ds_read_b64_tr_b16 v[144:145], v9 offset:4096
    ds_read_b64_tr_b16 v[146:147], v9 offset:4608
    ds_read_b64_tr_b16 v[148:149], v10 offset:4096
    ds_read_b64_tr_b16 v[150:151], v10 offset:4608
    ds_read_b64_tr_b16 v[152:153], v11 offset:4096
    ds_read_b64_tr_b16 v[154:155], v11 offset:4608
    ds_read_b64_tr_b16 v[156:157], v8 offset:8192
    ds_read_b64_tr_b16 v[158:159], v8 offset:8704
    ds_read_b64_tr_b16 v[160:161], v9 offset:8192
    ds_read_b64_tr_b16 v[162:163], v9 offset:8704
    ds_read_b64_tr_b16 v[164:165], v10 offset:8192
    ds_read_b64_tr_b16 v[166:167], v10 offset:8704
    ds_read_b64_tr_b16 v[168:169], v11 offset:8192
    ds_read_b64_tr_b16 v[170:171], v11 offset:8704
    s_waitcnt vmcnt(0)
    s_mov_b64 exec, 1
    s_cmp_eq_u32 s50, 1
    s_cbranch_scc0 L_slow_5
    buffer_store_dword v205, v204, s[40:43], s64 offen
L_join_6:
    s_mov_b64 exec, -1
    s_add_u32 m0, s91, 0
    s_mov_b32 s3, 0
    buffer_load_dwordx4 v122, s[24:27], s3 offen lds
    ds_read_b64_tr_b16 v[172:173], v8 offset:12288
    ds_read_b64_tr_b16 v[174:175], v8 offset:12800
    s_add_u32 m0, s91, 1024
    s_mov_b32 s3, 44032
    buffer_load_dwordx4 v122, s[24:27], s3 offen lds
    ds_read_b64_tr_b16 v[176:177], v9 offset:12288
    ds_read_b64_tr_b16 v[178:179], v9 offset:12800
    s_add_u32 m0, s91, 2048
    s_mov_b32 s3, 88064
    buffer_load_dwordx4 v122, s[24:27], s3 offen lds
    ds_read_b64_tr_b16 v[180:181], v10 offset:12288
    ds_read_b64_tr_b16 v[182:183], v10 offset:12800
    s_add_u32 m0, s91, 3072
    s_mov_b32 s3, 132096
    buffer_load_dwordx4 v122, s[24:27], s3 offen lds
    ds_read_b64_tr_b16 v[184:185], v11 offset:12288
    ds_read_b64_tr_b16 v[186:187], v11 offset:12800
    ds_read_b64_tr_b16 v[188:189], v8 offset:16384
    ds_read_b64_tr_b16 v[190:191], v8 offset:16896
    ds_read_b64_tr_b16 v[192:193], v9 offset:16384
    ds_read_b64_tr_b16 v[194:195], v9 offset:16896
    ds_read_b64_tr_b16 a[192:193], v10 offset:16384
    ds_read_b64_tr_b16 a[194:195], v10 offset:16896
    ds_read_b64_tr_b16 a[196:197], v11 offset:16384
    ds_read_b64_tr_b16 a[198:199], v11 offset:16896
    buffer_load_dword v207, v206, s[40:43], s64 offen sc1
    ds_read_b64_tr_b16 a[200:201], v8 offset:20480
    v_lshlrev_b32 v208, 16, v196
    ds_read_b64_tr_b16 a[202:203], v8 offset:20992
    v_and_b32 v209, 0xFFFF0000, v196
    ds_read_b64_tr_b16 a[204:205], v9 offset:20480
    v_pk_fma_f32 v[208:209], v[208:209], v[20:21], v[20:21] op_sel:[0,0,1] op_sel_hi:[1,0,1]
    ds_read_b64_tr_b16 a[206:207], v9 offset:20992
    v_lshlrev_b32 v210, 16, v197
    ds_read_b64_tr_b16 a[208:209], v10 offset:20480
    v_and_b32 v211, 0xFFFF0000, v197
    ds_read_b64_tr_b16 a[210:211], v10 offset:20992
    v_pk_fma_f32 v[210:211], v[210:211], v[20:21], v[20:21] op_sel:[0,0,1] op_sel_hi:[1,0,1]
    ds_read_b64_tr_b16 a[212:213], v11 offset:20480
    v_lshlrev_b32 v212, 16, v198
    ds_read_b64_tr_b16 a[214:215], v11 offset:20992
    v_and_b32 v213, 0xFFFF0000, v198
    ds_read_b64_tr_b16 a[216:217], v8 offset:24576
    v_pk_fma_f32 v[212:213], v[212:213], v[20:21], v[20:21] op_sel:[0,0,1] op_sel_hi:[1,0,1]
    ds_read_b64_tr_b16 a[218:219], v8 offset:25088
    v_lshlrev_b32 v214, 16, v199
    ds_read_b64_tr_b16 a[220:221], v9 offset:24576
    v_and_b32 v215, 0xFFFF0000, v199
    ds_read_b64_tr_b16 a[222:223], v9 offset:25088
    v_pk_fma_f32 v[214:215], v[214:215], v[20:21], v[20:21] op_sel:[0,0,1] op_sel_hi:[1,0,1]
    v_lshlrev_b32 v216, 16, v200
    v_and_b32 v217, 0xFFFF0000, v200
    v_pk_fma_f32 v[216:217], v[216:217], v[20:21], v[20:21] op_sel:[0,0,1] op_sel_hi:[1,0,1]
    v_lshlrev_b32 v218, 16, v201
    v_and_b32 v219, 0xFFFF0000, v201
    v_pk_fma_f32 v[218:219], v[218:219], v[20:21], v[20:21] op_sel:[0,0,1] op_sel_hi:[1,0,1]
    v_lshlrev_b32 v220, 16, v202
    v_and_b32 v221, 0xFFFF0000, v202
    v_pk_fma_f32 v[220:221], v[220:221], v[20:21], v[20:21] op_sel:[0,0,1] op_sel_hi:[1,0,1]
    v_lshlrev_b32 v222, 16, v203
    v_and_b32 v223, 0xFFFF0000, v203
    v_pk_fma_f32 v[222:223], v[222:223], v[20:21], v[20:21] op_sel:[0,0,1] op_sel_hi:[1,0,1]
    s_waitcnt vmcnt(0)
    v_cmp_ne_u32 vcc, s66, v207
    s_cbranch_vccnz L_oslow
L_ook:
    buffer_load_dwordx4 v[224:227], v13, s[40:43], s56 offen offset:0 sc1
    buffer_load_dwordx4 v[228:231], v13, s[40:43], s56 offen offset:1024 sc1
    buffer_load_dwordx4 v[232:235], v13, s[40:43], s57 offen offset:0 sc1
    buffer_load_dwordx4 v[236:239], v13, s[40:43], s57 offen offset:1024 sc1
    buffer_load_dwordx4 v[240:243], v13, s[40:43], s58 offen offset:0 sc1
    buffer_load_dwordx4 v[244:247], v13, s[40:43], s58 offen offset:1024 sc1
    s_waitcnt lgkmcnt(0)
    s_waitcnt vmcnt(5)
    v_mfma_f32_16x16x32_bf16 v[208:211], v[124:127], v[224:227], v[208:211]
    buffer_load_dwordx4 v[248:251], v13, s[40:43], s59 offen offset:0 sc1
    ds_read_b64_tr_b16 v[124:125], v10 offset:24576
    v_mfma_f32_16x16x32_bf16 v[212:215], v[128:131], v[224:227], v[212:215]
    ds_read_b64_tr_b16 v[126:127], v10 offset:25088
    ds_read_b64_tr_b16 v[128:129], v11 offset:24576
    v_mfma_f32_16x16x32_bf16 v[216:219], v[132:135], v[224:227], v[216:219]
    ds_read_b64_tr_b16 v[130:131], v11 offset:25088
    ds_read_b64_tr_b16 v[132:133], v8 offset:28672
    v_mfma_f32_16x16x32_bf16 v[220:223], v[136:139], v[224:227], v[220:223]
    ds_read_b64_tr_b16 v[134:135], v8 offset:29184
    s_waitcnt vmcnt(5)
    v_mfma_f32_16x16x32_bf16 v[208:211], v[140:143], v[228:231], v[208:211]
    buffer_load_dwordx4 v[252:255], v13, s[40:43], s59 offen offset:1024 sc1
    ds_read_b64_tr_b16 v[136:137], v9 offset:28672
    v_mfma_f32_16x16x32_bf16 v[212:215], v[144:147], v[228:231], v[212:215]
    ds_read_b64_tr_b16 v[138:139], v9 offset:29184
    ds_read_b64_tr_b16 v[140:141], v10 offset:28672
    v_mfma_f32_16x16x32_bf16 v[216:219], v[148:151], v[228:231], v[216:219]
    ds_read_b64_tr_b16 v[142:143], v10 offset:29184
    ds_read_b64_tr_b16 v[144:145], v11 offset:28672
    v_mfma_f32_16x16x32_bf16 v[220:223], v[152:155], v[228:231], v[220:223]
    ds_read_b64_tr_b16 v[146:147], v11 offset:29184
    s_waitcnt vmcnt(5)
    v_mfma_f32_16x16x32_bf16 v[208:211], v[156:159], v[232:235], v[208:211]
    buffer_load_dwordx4 v[224:227], v13, s[40:43], s60 offen offset:0 sc1
    ds_read_b64_tr_b16 v[148:149], v8 offset:32768
    v_mfma_f32_16x16x32_bf16 v[212:215], v[160:163], v[232:235], v[212:215]
    ds_read_b64_tr_b16 v[150:151], v8 offset:33280
    ds_read_b64_tr_b16 v[152:153], v9 offset:32768
    v_mfma_f32_16x16x32_bf16 v[216:219], v[164:167], v[232:235], v[216:219]
    ds_read_b64_tr_b16 v[154:155], v9 offset:33280
    ds_read_b64_tr_b16 v[156:157], v10 offset:32768
    v_mfma_f32_16x16x32_bf16 v[220:223], v[168:171], v[232:235], v[220:223]
    ds_read_b64_tr_b16 v[158:159], v10 offset:33280
    s_waitcnt vmcnt(5)
    v_mfma_f32_16x16x32_bf16 v[208:211], v[172:175], v[236:239], v[208:211]
    buffer_load_dwordx4 v[228:231], v13, s[40:43], s60 offen offset:1024 sc1
    ds_read_b64_tr_b16 v[160:161], v11 offset:32768
    v_mfma_f32_16x16x32_bf16 v[212:215], v[176:179], v[236:239], v[212:215]
    ds_read_b64_tr_b16 v[162:163], v11 offset:33280
    ds_read_b64_tr_b16 v[164:165], v8 offset:36864
    v_mfma_f32_16x16x32_bf16 v[216:219], v[180:183], v[236:239], v[216:219]
    ds_read_b64_tr_b16 v[166:167], v8 offset:37376
    ds_read_b64_tr_b16 v[168:169], v9 offset:36864
    v_mfma_f32_16x16x32_bf16 v[220:223], v[184:187], v[236:239], v[220:223]
    ds_read_b64_tr_b16 v[170:171], v9 offset:37376
    s_waitcnt vmcnt(5)
    v_mfma_f32_16x16x32_bf16 v[208:211], v[188:191], v[240:243], v[208:211]
    buffer_load_dwordx4 v[232:235], v13, s[40:43], s61 offen offset:0 sc1
    ds_read_b64_tr_b16 v[172:173], v10 offset:36864
    v_mfma_f32_16x16x32_bf16 v[212:215], v[192:195], v[240:243], v[212:215]
    ds_read_b64_tr_b16 v[174:175], v10 offset:37376
    ds_read_b64_tr_b16 v[176:177], v11 offset:36864
    v_mfma_f32_16x16x32_bf16 v[216:219], a[192:195], v[240:243], v[216:219]
    ds_read_b64_tr_b16 v[178:179], v11 offset:37376
    ds_read_b64_tr_b16 v[180:181], v8 offset:40960
    v_mfma_f32_16x16x32_bf16 v[220:223], a[196:199], v[240:243], v[220:223]
    ds_read_b64_tr_b16 v[182:183], v8 offset:41472
    s_waitcnt vmcnt(5)
    v_mfma_f32_16x16x32_bf16 v[208:211], a[200:203], v[244:247], v[208:211]
    buffer_load_dwordx4 v[236:239], v13, s[40:43], s61 offen offset:1024 sc1
    ds_read_b64_tr_b16 v[184:185], v9 offset:40960
    v_mfma_f32_16x16x32_bf16 v[212:215], a[204:207], v[244:247], v[212:215]
    ds_read_b64_tr_b16 v[186:187], v9 offset:41472
    ds_read_b64_tr_b16 v[188:189], v10 offset:40960
    v_mfma_f32_16x16x32_bf16 v[216:219], a[208:211], v[244:247], v[216:219]
    ds_read_b64_tr_b16 v[190:191], v10 offset:41472
    ds_read_b64_tr_b16 v[192:193], v11 offset:40960
    v_mfma_f32_16x16x32_bf16 v[220:223], a[212:215], v[244:247], v[220:223]
    ds_read_b64_tr_b16 v[194:195], v11 offset:41472
    s_waitcnt vmcnt(5) lgkmcnt(15)
    v_mfma_f32_16x16x32_bf16 v[208:211], a[216:219], v[248:251], v[208:211]
    buffer_load_dwordx4 v[240:243], v13, s[40:43], s62 offen offset:0 sc1
    ds_read_b64_tr_b16 a[192:193], v8 offset:45056
    v_mfma_f32_16x16x32_bf16 v[212:215], a[220:223], v[248:251], v[212:215]
    ds_read_b64_tr_b16 a[194:195], v8 offset:45568
    ds_read_b64_tr_b16 a[196:197], v9 offset:45056
    v_mfma_f32_16x16x32_bf16 v[216:219], v[124:127], v[248:251], v[216:219]
    ds_read_b64_tr_b16 a[198:199], v9 offset:45568
    ds_read_b64_tr_b16 a[200:201], v10 offset:45056
    v_mfma_f32_16x16x32_bf16 v[220:223], v[128:131], v[248:251], v[220:223]
    ds_read_b64_tr_b16 a[202:203], v10 offset:45568
    s_waitcnt vmcnt(5)
    v_mfma_f32_16x16x32_bf16 v[208:211], v[132:135], v[252:255], v[208:211]
    buffer_load_dwordx4 v[244:247], v13, s[40:43], s62 offen offset:1024 sc1
    ds_read_b64_tr_b16 a[204:205], v11 offset:45056
    v_mfma_f32_16x16x32_bf16 v[212:215], v[136:139], v[252:255], v[212:215]
    ds_read_b64_tr_b16 a[206:207], v11 offset:45568
    ds_read_b64_tr_b16 a[208:209], v8 offset:49152
    v_mfma_f32_16x16x32_bf16 v[216:219], v[140:143], v[252:255], v[216:219]
    ds_read_b64_tr_b16 a[210:211], v8 offset:49664
    ds_read_b64_tr_b16 a[212:213], v9 offset:49152
    v_mfma_f32_16x16x32_bf16 v[220:223], v[144:147], v[252:255], v[220:223]
    ds_read_b64_tr_b16 a[214:215], v9 offset:49664
    s_waitcnt vmcnt(5)
    v_mfma_f32_16x16x32_bf16 v[208:211], v[148:151], v[224:227], v[208:211]
    buffer_load_dwordx4 v[248:251], v13, s[40:43], s63 offen offset:0 sc1
    ds_read_b64_tr_b16 a[216:217], v10 offset:49152
    v_mfma_f32_16x16x32_bf16 v[212:215], v[152:155], v[224:227], v[212:215]
    ds_read_b64_tr_b16 a[218:219], v10 offset:49664
    ds_read_b64_tr_b16 a[220:221], v11 offset:49152
    v_mfma_f32_16x16x32_bf16 v[216:219], v[156:159], v[224:227], v[216:219]
    ds_read_b64_tr_b16 a[222:223], v11 offset:49664
    ds_read_b64_tr_b16 v[124:125], v8 offset:53248
    v_mfma_f32_16x16x32_bf16 v[220:223], v[160:163], v[224:227], v[220:223]
    ds_read_b64_tr_b16 v[126:127], v8 offset:53760
    s_waitcnt vmcnt(5) lgkmcnt(15)
    v_mfma_f32_16x16x32_bf16 v[208:211], v[164:167], v[228:231], v[208:211]
    buffer_load_dwordx4 v[252:255], v13, s[40:43], s63 offen offset:1024 sc1
    ds_read_b64_tr_b16 v[128:129], v9 offset:53248
    v_mfma_f32_16x16x32_bf16 v[212:215], v[168:171], v[228:231], v[212:215]
    ds_read_b64_tr_b16 v[130:131], v9 offset:53760
    ds_read_b64_tr_b16 v[132:133], v10 offset:53248
    v_mfma_f32_16x16x32_bf16 v[216:219], v[172:175], v[228:231], v[216:219]
    ds_read_b64_tr_b16 v[134:135], v10 offset:53760
    ds_read_b64_tr_b16 v[136:137], v11 offset:53248
    v_mfma_f32_16x16x32_bf16 v[220:223], v[176:179], v[228:231], v[220:223]
    ds_read_b64_tr_b16 v[138:139], v11 offset:53760
    s_waitcnt vmcnt(5)
    v_mfma_f32_16x16x32_bf16 v[208:211], v[180:183], v[232:235], v[208:211]
    ds_read_b64_tr_b16 v[140:141], v8 offset:57344
    ds_read_b64_tr_b16 v[142:143], v8 offset:57856
    v_mfma_f32_16x16x32_bf16 v[212:215], v[184:187], v[232:235], v[212:215]
    ds_read_b64_tr_b16 v[144:145], v9 offset:57344
    ds_read_b64_tr_b16 v[146:147], v9 offset:57856
    v_mfma_f32_16x16x32_bf16 v[216:219], v[188:191], v[232:235], v[216:219]
    ds_read_b64_tr_b16 v[148:149], v10 offset:57344
    ds_read_b64_tr_b16 v[150:151], v10 offset:57856
    v_mfma_f32_16x16x32_bf16 v[220:223], v[192:195], v[232:235], v[220:223]
    ds_read_b64_tr_b16 v[152:153], v11 offset:57344
    s_waitcnt vmcnt(4) lgkmcnt(15)
    v_mfma_f32_16x16x32_bf16 v[208:211], a[192:195], v[236:239], v[208:211]
    ds_read_b64_tr_b16 v[154:155], v11 offset:57856
    ds_read_b64_tr_b16 v[156:157], v8 offset:61440
    v_mfma_f32_16x16x32_bf16 v[212:215], a[196:199], v[236:239], v[212:215]
    ds_read_b64_tr_b16 v[158:159], v8 offset:61952
    ds_read_b64_tr_b16 v[160:161], v9 offset:61440
    v_mfma_f32_16x16x32_bf16 v[216:219], a[200:203], v[236:239], v[216:219]
    ds_read_b64_tr_b16 v[162:163], v9 offset:61952
    ds_read_b64_tr_b16 v[164:165], v10 offset:61440
    v_mfma_f32_16x16x32_bf16 v[220:223], a[204:207], v[236:239], v[220:223]
    ds_read_b64_tr_b16 v[166:167], v10 offset:61952
    s_waitcnt vmcnt(3)
    v_mfma_f32_16x16x32_bf16 v[208:211], a[208:211], v[240:243], v[208:211]
    ds_read_b64_tr_b16 v[168:169], v11 offset:61440
    ds_read_b64_tr_b16 v[170:171], v11 offset:61952
    v_mfma_f32_16x16x32_bf16 v[212:215], a[212:215], v[240:243], v[212:215]
    s_add_u32 m0, s91, 4096
    s_mov_b32 s3, 176128
    v_mfma_f32_16x16x32_bf16 v[216:219], a[216:219], v[240:243], v[216:219]
    buffer_load_dwordx4 v122, s[24:27], s3 offen lds
    s_add_u32 m0, s91, 5120
    v_mfma_f32_16x16x32_bf16 v[220:223], a[220:223], v[240:243], v[220:223]
    s_mov_b32 s3, 220160
    s_waitcnt vmcnt(3) lgkmcnt(15)
    v_mfma_f32_16x16x32_bf16 v[208:211], v[124:127], v[244:247], v[208:211]
    buffer_load_dwordx4 v122, s[24:27], s3 offen lds
    s_add_u32 m0, s91, 6144
    v_mfma_f32_16x16x32_bf16 v[212:215], v[128:131], v[244:247], v[212:215]
    s_mov_b32 s3, 264192
    buffer_load_dwordx4 v122, s[24:27], s3 offen lds
    v_mfma_f32_16x16x32_bf16 v[216:219], v[132:135], v[244:247], v[216:219]
    s_add_u32 m0, s91, 7168
    s_mov_b32 s3, 308224
    v_mfma_f32_16x16x32_bf16 v[220:223], v[136:139], v[244:247], v[220:223]
    buffer_load_dwordx4 v122, s[24:27], s3 offen lds
    s_waitcnt vmcnt(5) lgkmcnt(8)
    v_mfma_f32_16x16x32_bf16 v[208:211], v[140:143], v[248:251], v[208:211]
    s_add_u32 m0, s91, 32768
    s_mov_b32 s3, 0
    v_mfma_f32_16x16x32_bf16 v[212:215], v[144:147], v[248:251], v[212:215]
    buffer_load_dwordx4 v122, s[28:31], s3 offen lds
    s_add_u32 m0, s91, 33792
    v_mfma_f32_16x16x32_bf16 v[216:219], v[148:151], v[248:251], v[216:219]
    s_mov_b32 s3, 44032
    buffer_load_dwordx4 v122, s[28:31], s3 offen lds
    v_mfma_f32_16x16x32_bf16 v[220:223], v[152:155], v[248:251], v[220:223]
    s_add_u32 m0, s91, 34816
    s_waitcnt vmcnt(6) lgkmcnt(0)
    v_mfma_f32_16x16x32_bf16 v[208:211], v[156:159], v[252:255], v[208:211]
    s_mov_b32 s3, 88064
    buffer_load_dwordx4 v122, s[28:31], s3 offen lds
    v_mfma_f32_16x16x32_bf16 v[212:215], v[160:163], v[252:255], v[212:215]
    s_add_u32 m0, s91, 35840
    s_mov_b32 s3, 132096
    v_mfma_f32_16x16x32_bf16 v[216:219], v[164:167], v[252:255], v[216:219]
    buffer_load_dwordx4 v122, s[28:31], s3 offen lds
    s_add_u32 m0, s91, 36864
    v_mfma_f32_16x16x32_bf16 v[220:223], v[168:171], v[252:255], v[220:223]
    s_mov_b32 s3, 176128
    buffer_load_dwordx4 v122, s[28:31], s3 offen lds
    s_add_u32 m0, s91, 37888
    s_mov_b32 s3, 220160
    buffer_load_dwordx4 v122, s[28:31], s3 offen lds
    s_add_u32 m0, s91, 38912
    s_mov_b32 s3, 264192
    buffer_load_dwordx4 v122, s[28:31], s3 offen lds
    s_add_u32 m0, s91, 39936
    s_mov_b32 s3, 308224
    buffer_load_dwordx4 v122, s[28:31], s3 offen lds
    s_add_u32 s66, s66, 1
    s_mov_b32 s65, 4096
    v_cvt_pk_bf16_f32 v124, v208, v209
    v_cvt_pk_bf16_f32 v125, v210, v211
    v_cvt_pk_bf16_f32 v126, v212, v213
    v_cvt_pk_bf16_f32 v127, v214, v215
    s_nop 0
    v_permlane16_swap_b32 v124, v126
    v_permlane16_swap_b32 v125, v127
    v_cvt_pk_bf16_f32 v128, v216, v217
    v_cvt_pk_bf16_f32 v129, v218, v219
    v_cvt_pk_bf16_f32 v130, v220, v221
    v_cvt_pk_bf16_f32 v131, v222, v223
    v_mfma_f32_16x16x32_bf16 v[200:203], v[124:127], v[124:127], 0
    v_mfma_f32_16x16x32_bf16 v[196:199], v[50:53], v[124:127], 0
    v_permlane16_swap_b32 v128, v130
    v_permlane16_swap_b32 v129, v131
    s_nop 1
    v_mfma_f32_16x16x32_bf16 v[200:203], v[128:131], v[128:131], v[200:203]
    v_mfma_f32_16x16x32_bf16 v[196:199], v[54:57], v[128:131], v[196:199]
    s_lshl_b32 s68, s48, 6
    s_lshl_b32 s69, s47, 4
    s_add_u32 s68, s68, s69
    v_add_u32 v224, s68, v1
    s_lshl_b32 s68, s47, 2
    s_add_u32 s68, s68, 148496
    v_mov_b32 v225, s68
    v_mov_b32 v226, 148496
    v_cndmask_b32 v200, v200, v201, s[72:73]
    v_cndmask_b32 v202, v202, v203, s[72:73]
    v_cndmask_b32 v198, v200, v202, s[74:75]
    v_mov_b32 v199, s66
    s_mov_b64 exec, s[76:77]
    s_cmp_eq_u32 s50, 1
    s_cbranch_scc0 L_slow_7
    buffer_store_dwordx4 v[196:199], v15, s[40:43], 0 offen
L_join_8:
    s_mov_b64 exec, -1
    s_cmp_eq_u32 s55, 0
    s_cbranch_scc0 L_nox1
    s_cmp_eq_u32 s50, 1
    s_cbranch_scc0 L_slow_9
    buffer_store_dwordx4 v[124:127], v14, s[40:43], 0 offen
    buffer_store_dwordx4 v[128:131], v14, s[40:43], 0 offen offset:1024
L_join_10:
    s_waitcnt vmcnt(11)
    s_add_u32 s68, s49, 3
    v_xor_b32 v200, 32, v123
    v_mov_b32 v205, s68
    s_mov_b32 s26, 0
    s_mov_b32 s30, 0
    v_add_u32 v246, 131072, v3
    ds_read_b64_tr_b16 v[58:59], v123 offset:0
    ds_read_b64_tr_b16 v[60:61], v123 offset:256
    ds_read_b64_tr_b16 v[62:63], v200 offset:0
    ds_read_b64_tr_b16 v[64:65], v200 offset:256
    ds_read_b64_tr_b16 v[74:75], v123 offset:2048
    ds_read_b64_tr_b16 v[76:77], v123 offset:2304
    ds_read_b64_tr_b16 v[78:79], v200 offset:2048
    ds_read_b64_tr_b16 v[80:81], v200 offset:2304
    ds_read_b64_tr_b16 v[90:91], v123 offset:4096
    ds_read_b64_tr_b16 v[92:93], v123 offset:4352
    ds_read_b64_tr_b16 v[94:95], v200 offset:4096
    ds_read_b64_tr_b16 v[96:97], v200 offset:4352
    ds_read_b64_tr_b16 v[106:107], v123 offset:6144
    ds_read_b64_tr_b16 v[108:109], v123 offset:6400
    ds_read_b64_tr_b16 v[110:111], v200 offset:6144
    ds_read_b64_tr_b16 v[112:113], v200 offset:6400
    s_waitcnt vmcnt(0)
    s_mov_b64 exec, 1
    s_cmp_eq_u32 s50, 1
    s_cbranch_scc0 L_slow_11
    buffer_store_dword v205, v204, s[40:43], s64 offen offset:16
L_join_12:
    s_mov_b64 exec, -1
L_nox1:
    s_lshl_b32 s67, s55, 5
    s_add_u32 s67, s67, s48
    s_lshl_b32 s69, s67, 7
    s_add_u32 s69, s69, 196608
    s_lshl_b32 s67, s48, 4
    s_add_u32 s67, s67, s55
    s_lshl_b32 s67, s67, 10
    s_add_u32 s67, s67, 532480
L_spoll:
    buffer_load_dwordx4 v[212:215], v16, s[40:43], 0 offen sc1
    buffer_load_dwordx4 v[216:219], v16, s[40:43], s65 offen sc1
    s_sub_u32 s53, s53, 1
    s_cbranch_scc1 L_exit
    s_waitcnt vmcnt(0)
    v_cmp_ne_u32 vcc, s66, v215
    v_cmp_ne_u32 s[70:71], s66, v219
    s_or_b64 vcc, vcc, s[70:71]
    s_and_b64 exec, exec, vcc
    s_cbranch_scc1 L_spoll
    s_mov_b64 exec, -1
    v_pk_add_f32 v[212:213], v[212:213], v[216:217]
    v_add_f32 v215, v214, v218
    v_add_f32 v214, v214, v218
    v_permlane32_swap_b32 v212, v213
    s_nop 0
    v_permlane32_swap_b32 v214, v215
    v_add_f32 v212, v212, v213
    v_add_f32 v214, v214, v215
    s_nop 1
    v_permlane16_swap_b32 v212, v214
    v_add_f32 v213, v212, v214
    v_add_f32 v214, v212, v214
    s_nop 1
    v_permlane16_swap_b32 v213, v214
    v_mov_b32 v212, v213
    s_nop 1
    v_permlane32_swap_b32 v212, v213
    v_mul_f32 v216, 0xBB000000, v212
    v_mul_f32 v214, 0x3B000000, v214
    v_fma_f32 v214, -v216, v216, v214
    v_max_f32 v214, 0, v214
    v_add_f32 v218, 925353388, v214
    v_rsq_f32 v218, v218
    v_fma_f32 v223, v216, s54, v213
    v_mul_f32 v223, v223, v218
    v_ashrrev_i32 v213, 31, v223
    v_or_b32 v213, 0x80000000, v213
    v_xor_b32 v223, v223, v213
    v_and_b32 v223, 0xFFFFF800, v223
    v_or_b32 v223, v223, v224
    v_add_f32 v20, 1.0, v218
    v_mul_f32 v21, v216, v218
    v_max_u32_dpp v212, v223, v223 row_ror:8 row_mask:0xf bank_mask:0xf
    v_mul_f32 v217, v20, v20
    v_mov_b32 v213, 925353388
    v_max_u32_dpp v212, v212, v212 row_ror:4 row_mask:0xf bank_mask:0xf
    v_fma_f32 v217, v214, v217, v213
    v_mov_b32 v221, s66
    v_max_u32_dpp v212, v212, v212 row_ror:2 row_mask:0xf bank_mask:0xf
    v_rsq_f32 v217, v217
    v_bfe_u32 v222, v14, 8, 2
    v_max_u32_dpp v212, v212, v212 row_ror:1 row_mask:0xf bank_mask:0xf
    ds_write_b32 v225, v212
    buffer_load_dword v207, v206, s[40:43], s64 offen offset:16 sc1
    v_mul_f32 v217, v217, v20
    s_add_u32 s65, s45, s47
    s_lshl_b32 s65, s65, 26
    v_mov_b32 v224, s65
    v_lshlrev_b32 v132, 16, v124
    v_and_b32 v133, 0xFFFF0000, v124
    v_lshlrev_b32 v134, 16, v125
    v_and_b32 v135, 0xFFFF0000, v125
    v_lshlrev_b32 v136, 16, v126
    v_and_b32 v137, 0xFFFF0000, v126
    v_lshlrev_b32 v138, 16, v127
    v_and_b32 v139, 0xFFFF0000, v127
    s_waitcnt lgkmcnt(0)
    s_barrier
    ds_read_b128 v[228:231], v226
    v_lshlrev_b32 v140, 16, v128
    v_and_b32 v141, 0xFFFF0000, v128
    v_lshlrev_b32 v142, 16, v129
    v_and_b32 v143, 0xFFFF0000, v129
    v_lshlrev_b32 v144, 16, v130
    v_and_b32 v145, 0xFFFF0000, v130
    v_lshlrev_b32 v146, 16, v131
    v_and_b32 v147, 0xFFFF0000, v131
    v_lshlrev_b32 v222, 4, v222
    s_waitcnt lgkmcnt(0)
    v_max3_u32 v220, v228, v229, v230
    v_max_u32 v220, v220, v231
    s_mov_b64 exec, 1
    buffer_store_dwordx2 v[220:221], v224, s[16:19], s69 offen sc1
    s_mov_b64 exec, -1
    s_cmp_eq_u32 s55, 0
    s_cbranch_scc0 L_final
    s_nop 0
    s_lshl_b32 s87, s47, 12
    v_readfirstlane_b32 s82, v220
    v_and_b32 v209, 112, v3
    s_waitcnt vmcnt(1)
    v_cmp_ne_u32 vcc, s68, v207
    s_cbranch_vccnz L_xslow
L_xok:
    s_cmp_eq_u32 s45, 1
    s_cbranch_scc1 L_pub1
L_pubr:
    s_add_u32 m0, s87, 0
    s_lshl1_add_u32 s3, s92, 0
    buffer_load_dwordx4 v246, s[40:43], s3 offen sc1 lds
    s_lshl_b32 s66, s47, 6
    v_add_u32 v213, s66, v17
    buffer_load_dwordx4 v246, s[40:43], s3 offen offset:1024 sc1 lds
    ds_write2_b32 v213, v216, v217 offset0:16 offset1:96
    ds_write_b32 v213, v218 offset:704
    s_add_u32 m0, s87, 2048
    s_lshl1_add_u32 s3, s93, 0
    buffer_load_dwordx4 v246, s[40:43], s3 offen sc1 lds
    v_mov_b32 v4, v3
    v_add_u32 v5, 1024, v3
    buffer_load_dwordx4 v246, s[40:43], s3 offen offset:1024 sc1 lds
    v_lshl_add_u32 v202, v2, 7, v209
    v_cmp_gt_u32 vcc, 8, v1
    s_add_u32 m0, s87, 16384
    s_lshl1_add_u32 s3, s92, 16384
    buffer_load_dwordx4 v246, s[40:43], s3 offen sc1 lds
    v_add_u32 v202, 65536, v202
    v_add_u32 v203, 512, v202
    buffer_load_dwordx4 v246, s[40:43], s3 offen offset:1024 sc1 lds
    v_cndmask_b32 v6, v202, v6, vcc
    v_cndmask_b32 v7, v203, v7, vcc
    s_add_u32 m0, s87, 18432
    s_lshl1_add_u32 s3, s93, 16384
    buffer_load_dwordx4 v246, s[40:43], s3 offen sc1 lds
    buffer_load_dwordx4 v246, s[40:43], s3 offen offset:1024 sc1 lds
    s_cmp_eq_u32 s45, 1
    s_cbranch_scc1 L_pub3
    s_waitcnt vmcnt(4) lgkmcnt(0)
L_pubs:
    s_barrier
    s_cmp_eq_u32 s45, 1
    s_cselect_b32 s83, 1, 0
    s_cmp_lt_u32 s51, 43
    s_cselect_b32 s83, 3, s83
    s_cbranch_scc1 L_slow_ffn0
L_join_t1:
    ds_read_b128 a[192:195], v4 offset:0
    ds_read_b128 a[196:199], v5 offset:0
    ds_read_b128 a[200:203], v4 offset:2048
    ds_read_b128 a[204:207], v5 offset:2048
    ds_read_b128 a[208:211], v4 offset:4096
    ds_read_b128 a[212:215], v5 offset:4096
    s_waitcnt lgkmcnt(5)
    v_mfma_f32_16x16x32_bf16 v[160:163], a[4:7], a[192:195], 0
    ds_read_b128 a[216:219], v4 offset:6144
    v_mfma_f32_16x16x32_bf16 v[156:159], a[0:3], a[192:195], 0
    s_add_u32 m0, s87, 32768
    v_mfma_f32_16x16x32_bf16 v[164:167], a[192:195], a[8:11], 0
    s_lshl1_add_u32 s3, s92, 32768
    buffer_load_dwordx4 v246, s[40:43], s3 offen sc1 lds
    s_waitcnt lgkmcnt(5)
    v_mfma_f32_16x16x32_bf16 v[160:163], a[16:19], a[196:199], v[160:163]
    ds_read_b128 a[220:223], v5 offset:6144
    v_mfma_f32_16x16x32_bf16 v[156:159], a[12:15], a[196:199], v[156:159]
    s_lshl_b32 s66, s52, 7
    buffer_load_dwordx4 v246, s[40:43], s3 offen offset:1024 sc1 lds
    v_mfma_f32_16x16x32_bf16 v[164:167], a[196:199], a[20:23], v[164:167]
    s_waitcnt lgkmcnt(4)
    v_mfma_f32_16x16x32_bf16 v[160:163], a[28:31], a[200:203], v[160:163]
    ds_read_b128 a[192:195], v4 offset:8192
    s_add_u32 s66, s66, 131072
    v_mfma_f32_16x16x32_bf16 v[156:159], a[24:27], a[200:203], v[156:159]
    s_add_u32 m0, s87, 34816
    v_mfma_f32_16x16x32_bf16 v[164:167], a[200:203], a[32:35], v[164:167]
    s_lshl1_add_u32 s3, s93, 32768
    buffer_load_dwordx4 v246, s[40:43], s3 offen sc1 lds
    v_mfma_f32_16x16x32_bf16 v[160:163], a[40:43], a[204:207], v[160:163]
    ds_read_b128 a[196:199], v5 offset:8192
    v_mfma_f32_16x16x32_bf16 v[156:159], a[36:39], a[204:207], v[156:159]
    s_lshl_b32 s67, s52, 14
    buffer_load_dwordx4 v246, s[40:43], s3 offen offset:1024 sc1 lds
    v_mfma_f32_16x16x32_bf16 v[164:167], a[204:207], a[44:47], v[164:167]
    s_waitcnt lgkmcnt(4)
    v_mfma_f32_16x16x32_bf16 v[160:163], a[52:55], a[208:211], v[160:163]
    ds_read_b128 a[200:203], v4 offset:10240
    s_add_u32 s67, s67, 524288
    v_mfma_f32_16x16x32_bf16 v[156:159], a[48:51], a[208:211], v[156:159]
    s_add_u32 m0, s87, 49152
    v_mfma_f32_16x16x32_bf16 v[164:167], a[208:211], a[56:59], v[164:167]
    s_lshl1_add_u32 s3, s92, 49152
    buffer_load_dwordx4 v246, s[40:43], s3 offen sc1 lds
    v_mfma_f32_16x16x32_bf16 v[160:163], a[64:67], a[212:215], v[160:163]
    ds_read_b128 a[204:207], v5 offset:10240
    v_mfma_f32_16x16x32_bf16 v[156:159], a[60:63], a[212:215], v[156:159]
    s_add_u32 s64, s49, 2
    buffer_load_dwordx4 v246, s[40:43], s3 offen offset:1024 sc1 lds
    v_mfma_f32_16x16x32_bf16 v[164:167], a[212:215], a[68:71], v[164:167]
    s_waitcnt lgkmcnt(4)
    v_mfma_f32_16x16x32_bf16 v[160:163], a[76:79], a[216:219], v[160:163]
    ds_read_b128 a[208:211], v4 offset:12288
    s_cmp_eq_u32 s52, 255
    s_cselect_b32 s66, 2147418112, s66
    s_cselect_b32 s67, 2147418112, s67
    s_cselect_b32 s88, 0, s64
    v_mfma_f32_16x16x32_bf16 v[156:159], a[72:75], a[216:219], v[156:159]
    v_mfma_f32_16x16x32_bf16 v[164:167], a[216:219], a[80:83], v[164:167]
    v_mfma_f32_16x16x32_bf16 v[160:163], a[88:91], a[220:223], v[160:163]
    ds_read_b128 a[212:215], v5 offset:12288
    v_mfma_f32_16x16x32_bf16 v[156:159], a[84:87], a[220:223], v[156:159]
    s_add_u32 m0, s87, 51200
    s_lshl1_add_u32 s3, s93, 49152
    v_mfma_f32_16x16x32_bf16 v[164:167], a[220:223], a[92:95], v[164:167]
    s_waitcnt lgkmcnt(4)
    v_mfma_f32_16x16x32_bf16 v[160:163], a[100:103], a[192:195], v[160:163]
    ds_read_b128 a[216:219], v4 offset:14336
    buffer_load_dwordx4 v246, s[40:43], s3 offen sc1 lds
    v_mfma_f32_16x16x32_bf16 v[156:159], a[96:99], a[192:195], v[156:159]
    v_and_b32 v252, 112, v3
    v_mfma_f32_16x16x32_bf16 v[164:167], a[192:195], a[104:107], v[164:167]
    buffer_load_dwordx4 v246, s[40:43], s3 offen offset:1024 sc1 lds
    v_add_u32 v252, s66, v252
    v_mfma_f32_16x16x32_bf16 v[160:163], a[112:115], a[196:199], v[160:163]
    ds_read_b128 a[220:223], v5 offset:14336
    v_mfma_f32_16x16x32_bf16 v[156:159], a[108:111], a[196:199], v[156:159]
    v_mfma_f32_16x16x32_bf16 v[164:167], a[196:199], a[116:119], v[164:167]
    s_waitcnt lgkmcnt(4)
    v_mfma_f32_16x16x32_bf16 v[160:163], a[124:127], a[200:203], v[160:163]
    s_bitcmp1_b32 s83, 0
    s_cbranch_scc1 L_join_w1
    s_waitcnt vmcnt(8)
L_join_w1:
    s_barrier
    ds_read_b128 a[192:195], v4 offset:16384
    v_mfma_f32_16x16x32_bf16 v[156:159], a[120:123], a[200:203], v[156:159]
    v_add_u32 v253, s67, v3
    v_and_b32 v254, 1, v2
    v_mfma_f32_16x16x32_bf16 v[164:167], a[200:203], a[128:131], v[164:167]
    v_lshlrev_b32 v254, 16, v254
    v_sub_u32 v254, v12, v254
    v_mfma_f32_16x16x32_bf16 v[160:163], a[136:139], a[204:207], v[160:163]
    ds_read_b128 a[196:199], v5 offset:16384
    v_add_u32 v254, 49152, v254
    v_mfma_f32_16x16x32_bf16 v[156:159], a[132:135], a[204:207], v[156:159]
    ds_read2_b32 v[180:181], v17 offset0:16 offset1:96
    ds_read_b128 v[182:185], v18 offset:64
    v_mfma_f32_16x16x32_bf16 v[164:167], a[204:207], a[140:143], v[164:167]
    ds_read_b128 v[186:189], v18 offset:384
    s_waitcnt lgkmcnt(7)
    v_mfma_f32_16x16x32_bf16 v[160:163], a[148:151], a[208:211], v[160:163]
    ds_read_b128 a[200:203], v4 offset:18432
    v_mfma_f32_16x16x32_bf16 v[156:159], a[144:147], a[208:211], v[156:159]
    v_mfma_f32_16x16x32_bf16 v[164:167], a[208:211], a[152:155], v[164:167]
    v_mfma_f32_16x16x32_bf16 v[160:163], a[160:163], a[212:215], v[160:163]
    ds_read_b128 a[204:207], v5 offset:18432
    v_mfma_f32_16x16x32_bf16 v[156:159], a[156:159], a[212:215], v[156:159]
    v_mfma_f32_16x16x32_bf16 v[164:167], a[212:215], a[164:167], v[164:167]
    s_waitcnt lgkmcnt(7)
    v_mfma_f32_16x16x32_bf16 v[160:163], a[172:175], a[216:219], v[160:163]
    ds_read_b128 a[208:211], v4 offset:20480
    v_mfma_f32_16x16x32_bf16 v[156:159], a[168:171], a[216:219], v[156:159]
    v_mfma_f32_16x16x32_bf16 v[164:167], a[216:219], a[176:179], v[164:167]
    v_mfma_f32_16x16x32_bf16 v[160:163], a[184:187], a[220:223], v[160:163]
    ds_read_b128 a[212:215], v5 offset:20480
    v_mfma_f32_16x16x32_bf16 v[156:159], a[180:183], a[220:223], v[156:159]
    v_mfma_f32_16x16x32_bf16 v[164:167], a[220:223], a[188:191], v[164:167]
    s_waitcnt lgkmcnt(7)
    s_cmp_lt_u32 s51, 43
    s_cbranch_scc1 L_slow_rchk
L_join_t2:
    v_mfma_f32_16x16x32_bf16 v[172:175], a[4:7], a[192:195], 0
    ds_read_b128 a[216:219], v4 offset:22528
    v_mfma_f32_16x16x32_bf16 v[168:171], a[0:3], a[192:195], 0
    v_mfma_f32_16x16x32_bf16 v[176:179], a[192:195], a[8:11], 0
    v_mfma_f32_16x16x32_bf16 v[172:175], a[16:19], a[196:199], v[172:175]
    ds_read_b128 a[220:223], v5 offset:22528
    s_mov_b32 s65, 16384
    v_mfma_f32_16x16x32_bf16 v[168:171], a[12:15], a[196:199], v[168:171]
    s_waitcnt lgkmcnt(8)
    v_fmac_f32 v160, v44, v180
    v_fmac_f32 v156, v40, v180
    v_mfma_f32_16x16x32_bf16 v[176:179], a[196:199], a[20:23], v[176:179]
    v_fmac_f32 v161, v45, v180
    s_waitcnt lgkmcnt(4)
    v_mfma_f32_16x16x32_bf16 v[172:175], a[28:31], a[200:203], v[172:175]
    ds_read_b128 a[192:195], v4 offset:24576
    v_fmac_f32 v157, v41, v180
    v_mfma_f32_16x16x32_bf16 v[168:171], a[24:27], a[200:203], v[168:171]
    v_fmac_f32 v162, v46, v180
    v_fmac_f32 v158, v42, v180
    v_mfma_f32_16x16x32_bf16 v[176:179], a[200:203], a[32:35], v[176:179]
    v_fmac_f32 v163, v47, v180
    v_fmac_f32 v159, v43, v180
    v_mfma_f32_16x16x32_bf16 v[172:175], a[40:43], a[204:207], v[172:175]
    ds_read_b128 a[196:199], v5 offset:24576
    v_mul_f32 v160, v160, v181
    v_mfma_f32_16x16x32_bf16 v[168:171], a[36:39], a[204:207], v[168:171]
    v_mul_f32 v161, v161, v181
    v_mul_f32 v162, v162, v181
    v_mfma_f32_16x16x32_bf16 v[176:179], a[204:207], a[44:47], v[176:179]
    v_mul_f32 v163, v163, v181
    s_waitcnt lgkmcnt(4)
    v_mfma_f32_16x16x32_bf16 v[172:175], a[52:55], a[208:211], v[172:175]
    ds_read_b128 a[200:203], v4 offset:26624
    v_cvt_pk_bf16_f32 v124, v156, v157
    v_mfma_f32_16x16x32_bf16 v[168:171], a[48:51], a[208:211], v[168:171]
    v_cvt_pk_bf16_f32 v134, v160, v161
    v_cvt_pk_bf16_f32 v125, v158, v159
    v_mfma_f32_16x16x32_bf16 v[176:179], a[208:211], a[56:59], v[176:179]
    v_cvt_pk_bf16_f32 v135, v162, v163
    v_mul_f32 v152, 0x3EB8AA3B, v181
    v_mfma_f32_16x16x32_bf16 v[172:175], a[64:67], a[212:215], v[172:175]
    ds_read_b128 a[204:207], v5 offset:26624
    v_fmac_f32 v164, v182, v48
    v_mfma_f32_16x16x32_bf16 v[168:171], a[60:63], a[212:215], v[168:171]
    v_fmac_f32 v165, v183, v48
    v_fmac_f32 v166, v184, v48
    v_mfma_f32_16x16x32_bf16 v[176:179], a[212:215], a[68:71], v[176:179]
    v_fmac_f32 v167, v185, v48
    s_waitcnt lgkmcnt(4)
    v_mfma_f32_16x16x32_bf16 v[172:175], a[76:79], a[216:219], v[172:175]
    ds_read_b128 a[208:211], v4 offset:28672
    v_mul_f32 v164, v164, v186
    v_mfma_f32_16x16x32_bf16 v[168:171], a[72:75], a[216:219], v[168:171]
    v_mul_f32 v165, v165, v187
    v_mul_f32 v166, v166, v188
    v_mfma_f32_16x16x32_bf16 v[176:179], a[216:219], a[80:83], v[176:179]
    v_mul_f32 v167, v167, v189
    v_cvt_pk_bf16_f32 v144, v164, v165
    v_mfma_f32_16x16x32_bf16 v[172:175], a[88:91], a[220:223], v[172:175]
    ds_read_b128 a[212:215], v5 offset:28672
    v_cvt_pk_bf16_f32 v145, v166, v167
    v_mfma_f32_16x16x32_bf16 v[168:171], a[84:87], a[220:223], v[168:171]
    ds_read2_b32 v[190:191], v17 offset0:32 offset1:112
    ds_read_b128 v[192:195], v18 offset:128
    v_mfma_f32_16x16x32_bf16 v[176:179], a[220:223], a[92:95], v[176:179]
    ds_read_b128 v[196:199], v18 offset:448
    s_waitcnt lgkmcnt(7)
    v_mfma_f32_16x16x32_bf16 v[172:175], a[100:103], a[192:195], v[172:175]
    ds_read_b128 a[216:219], v4 offset:30720
    v_mfma_f32_16x16x32_bf16 v[168:171], a[96:99], a[192:195], v[168:171]
    v_mfma_f32_16x16x32_bf16 v[176:179], a[192:195], a[104:107], v[176:179]
    v_mfma_f32_16x16x32_bf16 v[172:175], a[112:115], a[196:199], v[172:175]
    ds_read_b128 a[220:223], v5 offset:30720
    v_mfma_f32_16x16x32_bf16 v[168:171], a[108:111], a[196:199], v[168:171]
    v_mfma_f32_16x16x32_bf16 v[176:179], a[196:199], a[116:119], v[176:179]
    s_waitcnt lgkmcnt(7)
    v_mfma_f32_16x16x32_bf16 v[172:175], a[124:127], a[200:203], v[172:175]
    s_bitcmp1_b32 s83, 1
    s_cbranch_scc1 L_join_w2
    s_waitcnt vmcnt(0)
L_join_w2:
    s_barrier
    ds_read_b128 a[192:195], v4 offset:32768
    v_mfma_f32_16x16x32_bf16 v[168:171], a[120:123], a[200:203], v[168:171]
    v_mfma_f32_16x16x32_bf16 v[176:179], a[200:203], a[128:131], v[176:179]
    v_mfma_f32_16x16x32_bf16 v[172:175], a[136:139], a[204:207], v[172:175]
    ds_read_b128 a[196:199], v5 offset:32768
    v_mfma_f32_16x16x32_bf16 v[168:171], a[132:135], a[204:207], v[168:171]
    v_mfma_f32_16x16x32_bf16 v[176:179], a[204:207], a[140:143], v[176:179]
    s_waitcnt lgkmcnt(7)
    v_mfma_f32_16x16x32_bf16 v[172:175], a[148:151], a[208:211], v[172:175]
    ds_read_b128 a[200:203], v4 offset:34816
    v_mfma_f32_16x16x32_bf16 v[168:171], a[144:147], a[208:211], v[168:171]
    v_mfma_f32_16x16x32_bf16 v[176:179], a[208:211], a[152:155], v[176:179]
    v_mfma_f32_16x16x32_bf16 v[172:175], a[160:163], a[212:215], v[172:175]
    ds_read_b128 a[204:207], v5 offset:34816
    v_mfma_f32_16x16x32_bf16 v[168:171], a[156:159], a[212:215], v[168:171]
    v_mfma_f32_16x16x32_bf16 v[176:179], a[212:215], a[164:167], v[176:179]
    s_waitcnt lgkmcnt(4)
    v_mfma_f32_16x16x32_bf16 v[172:175], a[172:175], a[216:219], v[172:175]
    ds_read_b128 a[208:211], v4 offset:36864
    v_mfma_f32_16x16x32_bf16 v[168:171], a[168:171], a[216:219], v[168:171]
    v_mfma_f32_16x16x32_bf16 v[176:179], a[216:219], a[176:179], v[176:179]
    v_mfma_f32_16x16x32_bf16 v[172:175], a[184:187], a[220:223], v[172:175]
    ds_read_b128 a[212:215], v5 offset:36864
    v_mfma_f32_16x16x32_bf16 v[168:171], a[180:183], a[220:223], v[168:171]
    v_mfma_f32_16x16x32_bf16 v[176:179], a[220:223], a[188:191], v[176:179]
    s_waitcnt lgkmcnt(4)
    v_mfma_f32_16x16x32_bf16 v[160:163], a[4:7], a[192:195], 0
    ds_read_b128 a[216:219], v4 offset:38912
    v_mfma_f32_16x16x32_bf16 v[156:159], a[0:3], a[192:195], 0
    v_mfma_f32_16x16x32_bf16 v[164:167], a[192:195], a[8:11], 0
    v_mfma_f32_16x16x32_bf16 v[160:163], a[16:19], a[196:199], v[160:163]
    ds_read_b128 a[220:223], v5 offset:38912
    v_fmac_f32 v172, v44, v190
    v_mfma_f32_16x16x32_bf16 v[156:159], a[12:15], a[196:199], v[156:159]
    v_fmac_f32 v168, v40, v190
    v_fmac_f32 v173, v45, v190
    v_mfma_f32_16x16x32_bf16 v[164:167], a[196:199], a[20:23], v[164:167]
    v_fmac_f32 v169, v41, v190
    s_waitcnt lgkmcnt(4)
    v_mfma_f32_16x16x32_bf16 v[160:163], a[28:31], a[200:203], v[160:163]
    ds_read_b128 a[192:195], v4 offset:40960
    v_fmac_f32 v174, v46, v190
    v_mfma_f32_16x16x32_bf16 v[156:159], a[24:27], a[200:203], v[156:159]
    v_fmac_f32 v170, v42, v190
    buffer_load_dwordx4 v[240:243], v252, s[16:19], 0 offen sc1
    v_mfma_f32_16x16x32_bf16 v[164:167], a[200:203], a[32:35], v[164:167]
    v_fmac_f32 v175, v47, v190
    v_fmac_f32 v171, v43, v190
    v_mfma_f32_16x16x32_bf16 v[160:163], a[40:43], a[204:207], v[160:163]
    ds_read_b128 a[196:199], v5 offset:40960
    v_mul_f32 v172, v172, v191
    v_mfma_f32_16x16x32_bf16 v[156:159], a[36:39], a[204:207], v[156:159]
    v_mul_f32 v173, v173, v191
    v_mul_f32 v174, v174, v191
    v_mfma_f32_16x16x32_bf16 v[164:167], a[204:207], a[44:47], v[164:167]
    v_mul_f32 v175, v175, v191
    s_waitcnt lgkmcnt(4)
    v_mfma_f32_16x16x32_bf16 v[160:163], a[52:55], a[208:211], v[160:163]
    ds_read_b128 a[200:203], v4 offset:43008
    buffer_load_dwordx4 v[244:247], v253, s[16:19], s92 offen sc1
    v_mfma_f32_16x16x32_bf16 v[156:159], a[48:51], a[208:211], v[156:159]
    v_cvt_pk_bf16_f32 v126, v168, v169
    v_cvt_pk_bf16_f32 v136, v172, v173
    v_mfma_f32_16x16x32_bf16 v[164:167], a[208:211], a[56:59], v[164:167]
    v_cvt_pk_bf16_f32 v127, v170, v171
    v_cvt_pk_bf16_f32 v137, v174, v175
    v_mfma_f32_16x16x32_bf16 v[160:163], a[64:67], a[212:215], v[160:163]
    ds_read_b128 a[204:207], v5 offset:43008
    v_mul_f32 v153, 0x3EB8AA3B, v191
    v_mfma_f32_16x16x16_bf16 v[202:205], v[134:135], v[126:127], v[22:25]
    v_mfma_f32_16x16x16_bf16 v[206:209], v[136:137], v[126:127], v[26:29]
    buffer_load_dwordx4 v[248:251], v253, s[16:19], s93 offen sc1
    v_fmac_f32 v176, v192, v48
    v_mfma_f32_16x16x32_bf16 v[156:159], a[60:63], a[212:215], v[156:159]
    v_fmac_f32 v177, v193, v48
    v_fmac_f32 v178, v194, v48
    v_mfma_f32_16x16x32_bf16 v[164:167], a[212:215], a[68:71], v[164:167]
    v_fmac_f32 v179, v195, v48
    s_waitcnt lgkmcnt(4)
    v_mfma_f32_16x16x32_bf16 v[160:163], a[76:79], a[216:219], v[160:163]
    ds_read_b128 a[208:211], v4 offset:45056
    v_mul_f32 v176, v176, v196
    v_mfma_f32_16x16x32_bf16 v[156:159], a[72:75], a[216:219], v[156:159]
    v_mul_f32 v177, v177, v197
    v_mul_f32 v178, v178, v198
    v_mfma_f32_16x16x32_bf16 v[164:167], a[216:219], a[80:83], v[164:167]
    v_mul_f32 v179, v179, v199
    v_cvt_pk_bf16_f32 v146, v176, v177
    v_mfma_f32_16x16x32_bf16 v[160:163], a[88:91], a[220:223], v[160:163]
    ds_read_b128 a[212:215], v5 offset:45056
    v_cvt_pk_bf16_f32 v147, v178, v179
    v_mfma_f32_16x16x32_bf16 v[156:159], a[84:87], a[220:223], v[156:159]
    ds_read2_b32 v[180:181], v17 offset0:48 offset1:128
    ds_read_b128 v[182:185], v18 offset:192
    v_mfma_f32_16x16x32_bf16 v[164:167], a[220:223], a[92:95], v[164:167]
    ds_read_b128 v[186:189], v18 offset:512
    s_waitcnt lgkmcnt(7)
    v_mfma_f32_16x16x32_bf16 v[160:163], a[100:103], a[192:195], v[160:163]
    ds_read_b128 a[216:219], v4 offset:47104
    v_max_f32 v202, v202, v206
    v_mfma_f32_16x16x32_bf16 v[156:159], a[96:99], a[192:195], v[156:159]
    v_max_f32 v203, v203, v207
    v_max_f32 v204, v204, v208
    v_mfma_f32_16x16x32_bf16 v[164:167], a[192:195], a[104:107], v[164:167]
    v_max_f32 v205, v205, v209
    v_max3_f32 v200, v202, v203, v204
    v_mfma_f32_16x16x32_bf16 v[160:163], a[112:115], a[196:199], v[160:163]
    ds_read_b128 a[220:223], v5 offset:47104
    v_max_f32 v200, v200, v205
    v_mfma_f32_16x16x32_bf16 v[156:159], a[108:111], a[196:199], v[156:159]
    v_mov_b32 v201, v200
    s_nop 1
    v_permlane32_swap_b32 v200, v201
    v_mfma_f32_16x16x32_bf16 v[164:167], a[196:199], a[116:119], v[164:167]
    v_max_f32 v206, v200, v201
    s_waitcnt lgkmcnt(7)
    v_mfma_f32_16x16x32_bf16 v[160:163], a[124:127], a[200:203], v[160:163]
    ds_read_b128 a[192:195], v4 offset:49152
    v_max_f32 v207, v200, v201
    v_mfma_f32_16x16x32_bf16 v[156:159], a[120:123], a[200:203], v[156:159]
    s_nop 0
    v_permlane16_swap_b32 v206, v207
    v_max_f32 v200, v206, v207
    v_mfma_f32_16x16x32_bf16 v[164:167], a[200:203], a[128:131], v[164:167]
    v_mul_f32 v200, v200, v153
    v_fma_f32 v202, v202, v153, -v200
    v_mfma_f32_16x16x32_bf16 v[160:163], a[136:139], a[204:207], v[160:163]
    ds_read_b128 a[196:199], v5 offset:49152
    v_fma_f32 v203, v203, v153, -v200
    v_mfma_f32_16x16x32_bf16 v[156:159], a[132:135], a[204:207], v[156:159]
    v_fma_f32 v204, v204, v153, -v200
    v_fma_f32 v205, v205, v153, -v200
    v_mfma_f32_16x16x32_bf16 v[164:167], a[204:207], a[140:143], v[164:167]
    s_waitcnt lgkmcnt(7)
    v_mfma_f32_16x16x32_bf16 v[160:163], a[148:151], a[208:211], v[160:163]
    ds_read_b128 a[200:203], v4 offset:51200
    v_mfma_f32_16x16x32_bf16 v[156:159], a[144:147], a[208:211], v[156:159]
    v_exp_f32 v202, v202
    v_mfma_f32_16x16x32_bf16 v[164:167], a[208:211], a[152:155], v[164:167]
    v_exp_f32 v203, v203
    v_mfma_f32_16x16x32_bf16 v[160:163], a[160:163], a[212:215], v[160:163]
    ds_read_b128 a[204:207], v5 offset:51200
    v_mfma_f32_16x16x32_bf16 v[156:159], a[156:159], a[212:215], v[156:159]
    v_exp_f32 v204, v204
    v_mfma_f32_16x16x32_bf16 v[164:167], a[212:215], a[164:167], v[164:167]
    s_waitcnt lgkmcnt(4)
    v_mfma_f32_16x16x32_bf16 v[160:163], a[172:175], a[216:219], v[160:163]
    ds_read_b128 a[208:211], v4 offset:53248
    v_mfma_f32_16x16x32_bf16 v[156:159], a[168:171], a[216:219], v[156:159]
    v_exp_f32 v205, v205
    v_mfma_f32_16x16x32_bf16 v[164:167], a[216:219], a[176:179], v[164:167]
    v_cvt_pk_bf16_f32 v200, v202, v203
    v_cvt_pk_bf16_f32 v201, v204, v205
    v_mfma_f32_16x16x32_bf16 v[160:163], a[184:187], a[220:223], v[160:163]
    ds_read_b128 a[212:215], v5 offset:53248
    v_and_b32 v206, v34, v200
    v_mfma_f32_16x16x32_bf16 v[156:159], a[180:183], a[220:223], v[156:159]
    v_and_b32 v207, v35, v201
    v_bfi_b32 v208, v34, 0, v200
    v_mfma_f32_16x16x32_bf16 v[164:167], a[220:223], a[188:191], v[164:167]
    v_bfi_b32 v209, v35, 0, v201
    v_mfma_f32_16x16x16_bf16 v[214:217], v[36:37], v[200:201], 0
    s_nop 0
    v_mfma_f32_16x16x32_bf16 v[210:213], v[144:147], v[206:209], 0
    s_waitcnt lgkmcnt(4)
    v_mfma_f32_16x16x32_bf16 v[172:175], a[4:7], a[192:195], 0
    ds_read_b128 a[216:219], v4 offset:55296
    s_waitcnt vmcnt(2)
    v_cmp_ne_u32 vcc, s88, v243
    v_mfma_f32_16x16x32_bf16 v[168:171], a[0:3], a[192:195], 0
    s_lshl_b32 s68, s47, 11
    s_add_u32 s68, s68, 65536
    v_mfma_f32_16x16x32_bf16 v[176:179], a[192:195], a[8:11], 0
    s_or_b32 s69, s89, vcc_hi
    v_mfma_f32_16x16x32_bf16 v[172:175], a[16:19], a[196:199], v[172:175]
    ds_read_b128 a[220:223], v5 offset:55296
    v_mfma_f32_16x16x32_bf16 v[168:171], a[12:15], a[196:199], v[168:171]
    s_or_b32 s69, s69, vcc_lo
    s_cbranch_scc1 L_slow_h
L_join_h:
    v_mfma_f32_16x16x32_bf16 v[176:179], a[196:199], a[20:23], v[176:179]
    s_waitcnt vmcnt(1)
    v_max3_u32 v243, v244, v245, v246
    s_waitcnt vmcnt(0)
    v_max3_u32 v243, v243, v247, v248
    v_max3_u32 v243, v243, v249, v250
    v_max_u32 v243, v243, v251
    v_cmp_eq_u32 vcc, -1, v243
    v_add_u32 v252, s68, v3
    s_cbranch_vccnz L_slow_hr
L_join_hr:
    s_waitcnt lgkmcnt(4)
    v_mfma_f32_16x16x32_bf16 v[172:175], a[28:31], a[200:203], v[172:175]
    ds_read_b128 a[192:195], v4 offset:57344
    v_mfma_f32_16x16x32_bf16 v[168:171], a[24:27], a[200:203], v[168:171]
    v_mfma_f32_16x16x32_bf16 v[176:179], a[200:203], a[32:35], v[176:179]
    ds_write_b128 v252, v[244:247]
    v_mfma_f32_16x16x32_bf16 v[172:175], a[40:43], a[204:207], v[172:175]
    ds_read_b128 a[196:199], v5 offset:57344
    ds_write_b128 v252, v[248:251] offset:1024
    v_mfma_f32_16x16x32_bf16 v[168:171], a[36:39], a[204:207], v[168:171]
    ds_write2_b32 v17, v240, v241 offset0:0 offset1:80
    ds_write_b32 v17, v242 offset:640
    v_mfma_f32_16x16x32_bf16 v[176:179], a[204:207], a[44:47], v[176:179]
    v_fmac_f32 v160, v44, v180
    s_waitcnt lgkmcnt(8)
    v_mfma_f32_16x16x32_bf16 v[172:175], a[52:55], a[208:211], v[172:175]
    ds_read_b128 a[200:203], v4 offset:59392
    v_fmac_f32 v156, v40, v180
    v_mfma_f32_16x16x32_bf16 v[168:171], a[48:51], a[208:211], v[168:171]
    v_fmac_f32 v161, v45, v180
    v_fmac_f32 v157, v41, v180
    v_mfma_f32_16x16x32_bf16 v[176:179], a[208:211], a[56:59], v[176:179]
    v_fmac_f32 v162, v46, v180
    v_fmac_f32 v158, v42, v180
    v_mfma_f32_16x16x32_bf16 v[172:175], a[64:67], a[212:215], v[172:175]
    ds_read_b128 a[204:207], v5 offset:59392
    v_fmac_f32 v163, v47, v180
    v_mfma_f32_16x16x32_bf16 v[168:171], a[60:63], a[212:215], v[168:171]
    v_fmac_f32 v159, v43, v180
    v_mul_f32 v160, v160, v181
    v_mfma_f32_16x16x32_bf16 v[176:179], a[212:215], a[68:71], v[176:179]
    v_mul_f32 v161, v161, v181
    s_waitcnt lgkmcnt(8)
    v_mfma_f32_16x16x32_bf16 v[172:175], a[76:79], a[216:219], v[172:175]
    ds_read_b128 a[208:211], v4 offset:61440
    v_mul_f32 v162, v162, v181
    v_mfma_f32_16x16x32_bf16 v[168:171], a[72:75], a[216:219], v[168:171]
    v_mul_f32 v163, v163, v181
    v_cvt_pk_bf16_f32 v128, v156, v157
    v_mfma_f32_16x16x32_bf16 v[176:179], a[216:219], a[80:83], v[176:179]
    v_cvt_pk_bf16_f32 v138, v160, v161
    v_cvt_pk_bf16_f32 v129, v158, v159
    v_mfma_f32_16x16x32_bf16 v[172:175], a[88:91], a[220:223], v[172:175]
    ds_read_b128 a[212:215], v5 offset:61440
    v_cvt_pk_bf16_f32 v139, v162, v163
    v_mfma_f32_16x16x32_bf16 v[168:171], a[84:87], a[220:223], v[168:171]
    v_mul_f32 v154, 0x3EB8AA3B, v181
    v_mfma_f32_16x16x16_bf16 v[220:223], v[136:137], v[128:129], v[22:25]
    v_mfma_f32_16x16x16_bf16 v[224:227], v[138:139], v[128:129], v[26:29]
    v_fmac_f32 v164, v182, v48
    v_fmac_f32 v165, v183, v48
    v_mfma_f32_16x16x32_bf16 v[176:179], a[220:223], a[92:95], v[176:179]
    v_fmac_f32 v166, v184, v48
    s_waitcnt lgkmcnt(7)
    v_mfma_f32_16x16x32_bf16 v[172:175], a[100:103], a[192:195], v[172:175]
    ds_read_b128 a[216:219], v4 offset:63488
    v_fmac_f32 v167, v185, v48
    v_mfma_f32_16x16x32_bf16 v[168:171], a[96:99], a[192:195], v[168:171]
    v_mul_f32 v164, v164, v186
    v_mul_f32 v165, v165, v187
    v_mfma_f32_16x16x32_bf16 v[176:179], a[192:195], a[104:107], v[176:179]
    v_mul_f32 v166, v166, v188
    v_mul_f32 v167, v167, v189
    v_mfma_f32_16x16x32_bf16 v[172:175], a[112:115], a[196:199], v[172:175]
    ds_read_b128 a[220:223], v5 offset:63488
    v_cvt_pk_bf16_f32 v148, v164, v165
    v_mfma_f32_16x16x32_bf16 v[168:171], a[108:111], a[196:199], v[168:171]
    v_cvt_pk_bf16_f32 v149, v166, v167
    ds_read2_b32 v[190:191], v17 offset0:64 offset1:144
    v_mfma_f32_16x16x32_bf16 v[176:179], a[196:199], a[116:119], v[176:179]
    ds_read_b128 v[192:195], v18 offset:256
    s_waitcnt lgkmcnt(6)
    v_mfma_f32_16x16x32_bf16 v[172:175], a[124:127], a[200:203], v[172:175]
    ds_read_b128 v[196:199], v18 offset:576
    s_waitcnt lgkmcnt(9)
    s_barrier
    ds_read_b128 a[192:195], v6 offset:0
    v_mfma_f32_16x16x32_bf16 v[168:171], a[120:123], a[200:203], v[168:171]
    v_and_b32 v242, 31, v0
    v_lshlrev_b32 v242, 7, v242
    v_mfma_f32_16x16x32_bf16 v[176:179], a[200:203], a[128:131], v[176:179]
    s_mov_b32 s68, 196608
    buffer_load_dwordx2 v[240:241], v242, s[16:19], s68 offen sc1
    v_mfma_f32_16x16x32_bf16 v[172:175], a[136:139], a[204:207], v[172:175]
    ds_read_b128 a[196:199], v7 offset:0
    v_mfma_f32_16x16x32_bf16 v[168:171], a[132:135], a[204:207], v[168:171]
    v_rcp_f32 v214, v214
    v_mfma_f32_16x16x32_bf16 v[176:179], a[204:207], a[140:143], v[176:179]
    v_mul_f32 v210, v210, v214
    s_waitcnt lgkmcnt(7)
    v_mfma_f32_16x16x32_bf16 v[172:175], a[148:151], a[208:211], v[172:175]
    ds_read_b128 a[200:203], v6 offset:1024
    v_mul_f32 v211, v211, v214
    v_mfma_f32_16x16x32_bf16 v[168:171], a[144:147], a[208:211], v[168:171]
    v_mul_f32 v212, v212, v214
    v_mul_f32 v213, v213, v214
    v_mfma_f32_16x16x32_bf16 v[176:179], a[208:211], a[152:155], v[176:179]
    v_cvt_pk_bf16_f32 v236, v210, v211
    v_cvt_pk_bf16_f32 v237, v212, v213
    v_mfma_f32_16x16x32_bf16 v[172:175], a[160:163], a[212:215], v[172:175]
    ds_read_b128 a[204:207], v7 offset:1024
    v_max_f32 v220, v220, v224
    v_mfma_f32_16x16x32_bf16 v[168:171], a[156:159], a[212:215], v[168:171]
    v_max_f32 v221, v221, v225
    v_max_f32 v222, v222, v226
    v_mfma_f32_16x16x32_bf16 v[176:179], a[212:215], a[164:167], v[176:179]
    v_max_f32 v223, v223, v227
    s_waitcnt lgkmcnt(7)
    v_mfma_f32_16x16x32_bf16 v[172:175], a[172:175], a[216:219], v[172:175]
    ds_read_b128 a[208:211], v6 offset:2048
    v_max3_f32 v218, v220, v221, v222
    v_mfma_f32_16x16x32_bf16 v[168:171], a[168:171], a[216:219], v[168:171]
    v_max_f32 v218, v218, v223
    v_mov_b32 v219, v218
    v_mfma_f32_16x16x32_bf16 v[176:179], a[216:219], a[176:179], v[176:179]
    s_nop 0
    v_permlane32_swap_b32 v218, v219
    v_max_f32 v224, v218, v219
    v_mfma_f32_16x16x32_bf16 v[172:175], a[184:187], a[220:223], v[172:175]
    ds_read_b128 a[212:215], v7 offset:2048
    v_max_f32 v225, v218, v219
    v_mfma_f32_16x16x32_bf16 v[168:171], a[180:183], a[220:223], v[168:171]
    s_nop 0
    v_permlane16_swap_b32 v224, v225
    v_max_f32 v218, v224, v225
    v_mfma_f32_16x16x32_bf16 v[176:179], a[220:223], a[188:191], v[176:179]
    v_mul_f32 v218, v218, v154
    s_waitcnt lgkmcnt(4)
    v_mfma_f32_16x16x32_bf16 v[160:163], a[4:7], a[192:195], 0
    ds_read_b128 a[216:219], v6 offset:3072
    ds_read2_b32 v[180:181], v17 offset0:0 offset1:80
    v_mfma_f32_16x16x32_bf16 v[164:167], a[192:195], a[8:11], 0
    ds_read_b128 v[182:185], v18 offset:0
    ds_read_b128 v[186:189], v18 offset:320
    v_mfma_f32_16x16x32_bf16 v[160:163], a[16:19], a[196:199], v[160:163]
    ds_read_b128 a[220:223], v7 offset:3072
    v_fma_f32 v220, v220, v154, -v218
    v_mfma_f32_16x16x32_bf16 v[164:167], a[196:199], a[20:23], v[164:167]
    v_fma_f32 v221, v221, v154, -v218
    s_waitcnt lgkmcnt(7)
    v_mfma_f32_16x16x32_bf16 v[160:163], a[28:31], a[200:203], v[160:163]
    ds_read_b128 a[192:195], v6 offset:4096
    v_fma_f32 v222, v222, v154, -v218
    v_mfma_f32_16x16x32_bf16 v[164:167], a[200:203], a[32:35], v[164:167]
    v_fma_f32 v223, v223, v154, -v218
    v_mfma_f32_16x16x32_bf16 v[160:163], a[40:43], a[204:207], v[160:163]
    ds_read_b128 a[196:199], v7 offset:4096
    v_mfma_f32_16x16x32_bf16 v[164:167], a[204:207], a[44:47], v[164:167]
    s_waitcnt lgkmcnt(7)
    v_mfma_f32_16x16x32_bf16 v[160:163], a[52:55], a[208:211], v[160:163]
    ds_read_b128 a[200:203], v6 offset:5120
    v_mfma_f32_16x16x32_bf16 v[164:167], a[208:211], a[56:59], v[164:167]
    v_exp_f32 v220, v220
    v_mfma_f32_16x16x32_bf16 v[160:163], a[64:67], a[212:215], v[160:163]
    ds_read_b128 a[204:207], v7 offset:5120
    v_mfma_f32_16x16x32_bf16 v[164:167], a[212:215], a[68:71], v[164:167]
    s_waitcnt lgkmcnt(4)
    v_mfma_f32_16x16x32_bf16 v[160:163], a[76:79], a[216:219], v[160:163]
    ds_read_b128 a[208:211], v6 offset:6144
    v_mfma_f32_16x16x32_bf16 v[164:167], a[216:219], a[80:83], v[164:167]
    v_exp_f32 v221, v221
    v_mfma_f32_16x16x32_bf16 v[160:163], a[88:91], a[220:223], v[160:163]
    ds_read_b128 a[212:215], v7 offset:6144
    v_mfma_f32_16x16x32_bf16 v[164:167], a[220:223], a[92:95], v[164:167]
    s_waitcnt lgkmcnt(4)
    v_mfma_f32_16x16x32_bf16 v[160:163], a[100:103], a[192:195], v[160:163]
    ds_read_b128 a[216:219], v6 offset:7168
    v_mfma_f32_16x16x32_bf16 v[164:167], a[192:195], a[104:107], v[164:167]
    v_exp_f32 v222, v222
    v_mfma_f32_16x16x32_bf16 v[160:163], a[112:115], a[196:199], v[160:163]
    ds_read_b128 a[220:223], v7 offset:7168
    v_mfma_f32_16x16x32_bf16 v[164:167], a[196:199], a[116:119], v[164:167]
    s_waitcnt lgkmcnt(4)
    v_mfma_f32_16x16x32_bf16 v[160:163], a[124:127], a[200:203], v[160:163]
    v_exp_f32 v223, v223
    v_mfma_f32_16x16x32_bf16 v[164:167], a[200:203], a[128:131], v[164:167]
    v_cvt_pk_bf16_f32 v218, v220, v221
    v_cvt_pk_bf16_f32 v219, v222, v223
    v_mfma_f32_16x16x32_bf16 v[160:163], a[136:139], a[204:207], v[160:163]
    v_and_b32 v224, v34, v218
    v_and_b32 v225, v35, v219
    v_mfma_f32_16x16x32_bf16 v[164:167], a[204:207], a[140:143], v[164:167]
    v_bfi_b32 v226, v34, 0, v218
    s_waitcnt lgkmcnt(2)
    v_mfma_f32_16x16x32_bf16 v[160:163], a[148:151], a[208:211], v[160:163]
    v_bfi_b32 v227, v35, 0, v219
    v_mfma_f32_16x16x16_bf16 v[232:235], v[36:37], v[218:219], 0
    s_nop 0
    v_mfma_f32_16x16x32_bf16 v[228:231], v[146:149], v[224:227], 0
    v_fmac_f32 v172, v44, v190
    v_fmac_f32 v168, v40, v190
    v_mfma_f32_16x16x32_bf16 v[164:167], a[208:211], a[152:155], v[164:167]
    v_fmac_f32 v173, v45, v190
    v_fmac_f32 v169, v41, v190
    v_mfma_f32_16x16x32_bf16 v[160:163], a[160:163], a[212:215], v[160:163]
    v_fmac_f32 v174, v46, v190
    v_fmac_f32 v170, v42, v190
    v_mfma_f32_16x16x32_bf16 v[164:167], a[212:215], a[164:167], v[164:167]
    v_fmac_f32 v175, v47, v190
    s_waitcnt lgkmcnt(0)
    v_mfma_f32_16x16x32_bf16 v[160:163], a[172:175], a[216:219], v[160:163]
    v_fmac_f32 v171, v43, v190
    v_mul_f32 v172, v172, v191
    v_mfma_f32_16x16x32_bf16 v[164:167], a[216:219], a[176:179], v[164:167]
    v_mul_f32 v173, v173, v191
    v_mul_f32 v174, v174, v191
    v_mfma_f32_16x16x32_bf16 v[160:163], a[184:187], a[220:223], v[160:163]
    v_mul_f32 v175, v175, v191
    v_cvt_pk_bf16_f32 v130, v168, v169
    v_mfma_f32_16x16x32_bf16 v[164:167], a[220:223], a[188:191], v[164:167]
    v_cvt_pk_bf16_f32 v140, v172, v173
    v_cvt_pk_bf16_f32 v131, v170, v171
    v_cvt_pk_bf16_f32 v141, v174, v175
    v_mul_f32 v155, 0x3EB8AA3B, v191
    v_mfma_f32_16x16x16_bf16 v[202:205], v[138:139], v[130:131], v[22:25]
    v_mfma_f32_16x16x16_bf16 v[206:209], v[140:141], v[130:131], v[26:29]
    v_rcp_f32 v232, v232
    s_nop 0
    v_mul_f32 v228, v228, v232
    v_mul_f32 v229, v229, v232
    v_mul_f32 v230, v230, v232
    v_mul_f32 v231, v231, v232
    v_cvt_pk_bf16_f32 v238, v228, v229
    v_cvt_pk_bf16_f32 v239, v230, v231
    v_fmac_f32 v176, v192, v48
    v_fmac_f32 v177, v193, v48
    v_fmac_f32 v178, v194, v48
    v_fmac_f32 v179, v195, v48
    v_permlane16_swap_b32 v236, v238
    v_permlane16_swap_b32 v237, v239
    s_cmp_eq_u32 s50, 1
    s_cbranch_scc0 L_slow_13
    buffer_store_dwordx4 v[236:239], v12, s[40:43], s65 offen
L_join_14:
    v_mul_f32 v176, v176, v196
    s_waitcnt vmcnt(1)
    v_cmp_ne_u32 s[70:71], s64, v241
    v_mul_f32 v177, v177, v197
    v_max_u32_dpp v240, v240, v240 row_ror:8 row_mask:0xf bank_mask:0xf
    v_mul_f32 v178, v178, v198
    s_nop 0
    v_max_u32_dpp v240, v240, v240 row_ror:4 row_mask:0xf bank_mask:0xf
    v_mul_f32 v179, v179, v199
    s_nop 0
    v_max_u32_dpp v240, v240, v240 row_ror:2 row_mask:0xf bank_mask:0xf
    v_cvt_pk_bf16_f32 v150, v176, v177
    s_nop 0
    v_max_u32_dpp v240, v240, v240 row_ror:1 row_mask:0xf bank_mask:0xf
    v_cvt_pk_bf16_f32 v151, v178, v179
    v_readlane_b32 s66, v240, 0
    v_readlane_b32 s67, v240, 16
    s_waitcnt lgkmcnt(0)
    s_max_u32 s82, s66, s67
    s_cmp_eq_u64 s[70:71], 0
    s_cbranch_scc0 L_bslow
L_bok:
    s_mov_b32 s55, 1
    s_bfe_u32 s64, s82, 0x50006
    s_and_b32 s65, s82, 63
    s_and_b32 s66, s64, 3
    s_cmp_eq_u32 s66, 3
    s_cselect_b32 s66, 33, 3
    s_cmp_ge_u32 s65, 57
    s_cselect_b32 s66, s66, 1
    s_lshl_b32 s90, s66, s64
    s_bitcmp1_b32 s90, s48
    s_cbranch_scc1 L_patch
    v_max_f32 v202, v202, v206
    v_max_f32 v203, v203, v207
    v_max_f32 v204, v204, v208
    v_max_f32 v205, v205, v209
    v_max3_f32 v200, v202, v203, v204
    v_max_f32 v200, v200, v205
    v_pk_fma_f32 v[160:161], v[44:45], v[180:181], v[160:161] op_sel_hi:[1,0,1]
    v_pk_fma_f32 v[162:163], v[46:47], v[180:181], v[162:163] op_sel_hi:[1,0,1]
    v_pk_mul_f32 v[160:161], v[160:161], v[180:181] op_sel:[0,1] op_sel_hi:[1,1]
    v_pk_mul_f32 v[162:163], v[162:163], v[180:181] op_sel:[0,1] op_sel_hi:[1,1]
    v_cvt_pk_bf16_f32 v132, v160, v161
    v_cvt_pk_bf16_f32 v133, v162, v163
    v_lshrrev_b32 v248, 1, v2
    v_lshlrev_b32 v248, 8, v248
    v_mfma_f32_16x16x16_bf16 v[220:223], v[132:133], v[124:125], v[30:33]
    v_mfma_f32_16x16x16_bf16 v[224:227], v[134:135], v[124:125], v[26:29]
    v_lshl_add_u32 v248, v1, 4, v248
    v_and_b32 v249, 1, v2
    v_lshl_add_u32 v248, v249, 3, v248
    v_add_u32 v248, s85, v248
    v_add_u32 v249, 512, v248
    v_add_u32 v250, 1024, v248
    v_add_u32 v251, 1536, v248
    v_pk_fma_f32 v[164:165], v[182:183], v[48:49], v[164:165] op_sel_hi:[1,0,1]
    v_pk_fma_f32 v[166:167], v[184:185], v[48:49], v[166:167] op_sel_hi:[1,0,1]
    v_pk_mul_f32 v[164:165], v[164:165], v[186:187]
    v_pk_mul_f32 v[166:167], v[166:167], v[188:189]
    v_cvt_pk_bf16_f32 v142, v164, v165
    v_cvt_pk_bf16_f32 v143, v166, v167
    v_max_f32 v220, v220, v224
    v_max_f32 v221, v221, v225
    v_max_f32 v222, v222, v226
    v_max_f32 v223, v223, v227
    v_max3_f32 v218, v220, v221, v222
    v_max_f32 v218, v218, v223
    s_nop 1
    v_permlane32_swap_b32 v200, v218
    v_max_f32 v201, v200, v218
    v_max_f32 v219, v200, v218
    s_nop 1
    v_permlane16_swap_b32 v201, v219
    v_max_f32 v200, v201, v219
    v_max_f32 v218, v201, v219
    s_nop 1
    v_permlane32_swap_b32 v200, v218
    v_mul_f32 v200, v200, v155
    v_mul_f32 v218, v218, v152
    v_pk_fma_f32 v[202:203], v[202:203], v[154:155], v[200:201] op_sel:[0,1,0] op_sel_hi:[1,1,0] neg_lo:[0,0,1] neg_hi:[0,0,1]
    v_pk_fma_f32 v[220:221], v[220:221], v[152:153], v[218:219] op_sel:[0,0,0] op_sel_hi:[1,0,0] neg_lo:[0,0,1] neg_hi:[0,0,1]
    v_pk_fma_f32 v[204:205], v[204:205], v[154:155], v[200:201] op_sel:[0,1,0] op_sel_hi:[1,1,0] neg_lo:[0,0,1] neg_hi:[0,0,1]
    v_pk_fma_f32 v[222:223], v[222:223], v[152:153], v[218:219] op_sel:[0,0,0] op_sel_hi:[1,0,0] neg_lo:[0,0,1] neg_hi:[0,0,1]
    v_exp_f32 v202, v202
    v_exp_f32 v220, v220
    v_exp_f32 v203, v203
    v_exp_f32 v221, v221
    v_exp_f32 v204, v204
    v_exp_f32 v222, v222
    v_exp_f32 v205, v205
    v_exp_f32 v223, v223
    v_cvt_pk_bf16_f32 v200, v202, v203
    v_cvt_pk_bf16_f32 v218, v220, v221
    v_cvt_pk_bf16_f32 v201, v204, v205
    v_cvt_pk_bf16_f32 v219, v222, v223
    v_and_b32 v206, v34, v200
    v_and_b32 v224, v34, v218
    v_and_b32 v207, v35, v201
    v_and_b32 v225, v35, v219
    v_bfi_b32 v208, v34, 0, v200
    v_bfi_b32 v226, v34, 0, v218
    v_bfi_b32 v209, v35, 0, v201
    v_bfi_b32 v227, v35, 0, v219
    v_mfma_f32_16x16x16_bf16 v[214:217], v[36:37], v[200:201], 0
    v_mfma_f32_16x16x32_bf16 v[210:213], v[148:151], v[206:209], 0
    v_mfma_f32_16x16x16_bf16 v[232:235], v[36:37], v[218:219], 0
    v_mfma_f32_16x16x32_bf16 v[228:231], v[142:145], v[224:227], 0
    s_nop 4
    v_rcp_f32 v214, v214
    s_nop 0
    v_rcp_f32 v232, v232
    v_pk_mul_f32 v[210:211], v[210:211], v[214:215] op_sel_hi:[1,0]
    v_pk_mul_f32 v[228:229], v[228:229], v[232:233] op_sel_hi:[1,0]
    v_pk_mul_f32 v[212:213], v[212:213], v[214:215] op_sel_hi:[1,0]
    v_pk_mul_f32 v[230:231], v[230:231], v[232:233] op_sel_hi:[1,0]
    v_cvt_pk_bf16_f32 v236, v210, v211
    v_cvt_pk_bf16_f32 v238, v228, v229
    v_cvt_pk_bf16_f32 v237, v212, v213
    v_cvt_pk_bf16_f32 v239, v230, v231
    v_permlane16_swap_b32 v236, v238
    s_nop 0
    v_permlane16_swap_b32 v237, v239
    s_cmp_eq_u32 s50, 1
    s_cbranch_scc0 L_slow_15
    buffer_store_dwordx4 v[236:239], v254, s[40:43], 0 offen
L_join_16:
    s_branch L_oh
L_patch:
    s_lshl_b32 s68, s47, 8
    s_add_u32 s68, s68, 534528
    v_lshlrev_b32 v240, 14, v2
    v_cmp_gt_u32 vcc, 3, v2
    v_lshl_add_u32 v240, v1, 4, v240
    v_add_u32 v240, s68, v240
    v_mov_b32 v241, 2147418112
    v_cndmask_b32 v241, v241, v240, vcc
    s_mov_b32 s3, 0
    buffer_load_dwordx4 a[192:195], v240, s[16:19], s3 offen sc1
    v_max_f32 v202, v202, v206
    v_max_f32 v203, v203, v207
    v_max_f32 v204, v204, v208
    v_max_f32 v205, v205, v209
    v_max3_f32 v200, v202, v203, v204
    v_max_f32 v200, v200, v205
    v_pk_fma_f32 v[160:161], v[44:45], v[180:181], v[160:161] op_sel_hi:[1,0,1]
    v_pk_fma_f32 v[162:163], v[46:47], v[180:181], v[162:163] op_sel_hi:[1,0,1]
    v_pk_mul_f32 v[160:161], v[160:161], v[180:181] op_sel:[0,1] op_sel_hi:[1,1]
    v_pk_mul_f32 v[162:163], v[162:163], v[180:181] op_sel:[0,1] op_sel_hi:[1,1]
    v_cvt_pk_bf16_f32 v132, v160, v161
    v_cvt_pk_bf16_f32 v133, v162, v163
    s_mov_b32 s3, 65536
    buffer_load_dwordx4 a[196:199], v240, s[16:19], s3 offen sc1
    v_lshrrev_b32 v248, 1, v2
    v_lshlrev_b32 v248, 8, v248
    v_mfma_f32_16x16x16_bf16 v[220:223], v[132:133], v[124:125], v[30:33]
    v_mfma_f32_16x16x16_bf16 v[224:227], v[134:135], v[124:125], v[26:29]
    v_lshl_add_u32 v248, v1, 4, v248
    v_and_b32 v249, 1, v2
    v_lshl_add_u32 v248, v249, 3, v248
    v_add_u32 v248, s85, v248
    v_add_u32 v249, 512, v248
    v_add_u32 v250, 1024, v248
    v_add_u32 v251, 1536, v248
    v_pk_fma_f32 v[164:165], v[182:183], v[48:49], v[164:165] op_sel_hi:[1,0,1]
    s_mov_b32 s3, 131072
    buffer_load_dwordx4 a[200:203], v240, s[16:19], s3 offen sc1
    v_pk_fma_f32 v[166:167], v[184:185], v[48:49], v[166:167] op_sel_hi:[1,0,1]
    v_pk_mul_f32 v[164:165], v[164:165], v[186:187]
    v_pk_mul_f32 v[166:167], v[166:167], v[188:189]
    v_cvt_pk_bf16_f32 v142, v164, v165
    v_cvt_pk_bf16_f32 v143, v166, v167
    v_max_f32 v220, v220, v224
    v_max_f32 v221, v221, v225
    v_max_f32 v222, v222, v226
    v_max_f32 v223, v223, v227
    v_max3_f32 v218, v220, v221, v222
    v_max_f32 v218, v218, v223
    s_nop 1
    v_permlane32_swap_b32 v200, v218
    s_mov_b32 s3, 196608
    buffer_load_dwordx4 a[204:207], v240, s[16:19], s3 offen sc1
    v_max_f32 v201, v200, v218
    v_max_f32 v219, v200, v218
    s_nop 1
    v_permlane16_swap_b32 v201, v219
    v_max_f32 v200, v201, v219
    v_max_f32 v218, v201, v219
    s_nop 1
    v_permlane32_swap_b32 v200, v218
    v_mul_f32 v200, v200, v155
    v_mul_f32 v218, v218, v152
    v_pk_fma_f32 v[202:203], v[202:203], v[154:155], v[200:201] op_sel:[0,1,0] op_sel_hi:[1,1,0] neg_lo:[0,0,1] neg_hi:[0,0,1]
    v_pk_fma_f32 v[220:221], v[220:221], v[152:153], v[218:219] op_sel:[0,0,0] op_sel_hi:[1,0,0] neg_lo:[0,0,1] neg_hi:[0,0,1]
    v_pk_fma_f32 v[204:205], v[204:205], v[154:155], v[200:201] op_sel:[0,1,0] op_sel_hi:[1,1,0] neg_lo:[0,0,1] neg_hi:[0,0,1]
    v_pk_fma_f32 v[222:223], v[222:223], v[152:153], v[218:219] op_sel:[0,0,0] op_sel_hi:[1,0,0] neg_lo:[0,0,1] neg_hi:[0,0,1]
    s_mov_b32 s3, 262144
    buffer_load_dwordx4 a[208:211], v240, s[16:19], s3 offen sc1
    v_exp_f32 v202, v202
    v_exp_f32 v220, v220
    v_exp_f32 v203, v203
    v_exp_f32 v221, v221
    v_exp_f32 v204, v204
    v_exp_f32 v222, v222
    v_exp_f32 v205, v205
    v_exp_f32 v223, v223
    v_cvt_pk_bf16_f32 v200, v202, v203
    v_cvt_pk_bf16_f32 v218, v220, v221
    v_cvt_pk_bf16_f32 v201, v204, v205
    v_cvt_pk_bf16_f32 v219, v222, v223
    s_mov_b32 s3, 327680
    buffer_load_dwordx4 a[212:215], v240, s[16:19], s3 offen sc1
    v_and_b32 v206, v34, v200
    v_and_b32 v224, v34, v218
    v_and_b32 v207, v35, v201
    v_and_b32 v225, v35, v219
    v_bfi_b32 v208, v34, 0, v200
    v_bfi_b32 v226, v34, 0, v218
    v_bfi_b32 v209, v35, 0, v201
    v_bfi_b32 v227, v35, 0, v219
    v_mfma_f32_16x16x16_bf16 v[214:217], v[36:37], v[200:201], 0
    v_mfma_f32_16x16x32_bf16 v[210:213], v[148:151], v[206:209], 0
    v_mfma_f32_16x16x16_bf16 v[232:235], v[36:37], v[218:219], 0
    v_mfma_f32_16x16x32_bf16 v[228:231], v[142:145], v[224:227], 0
    s_and_b32 s84, s82, 15
    s_lshr_b32 s66, s65, 4
    s_add_u32 s83, s66, 1
    s_lshl_b32 s66, s66, 14
    s_lshl_b32 s67, s84, 4
    s_add_u32 s66, s66, s67
    s_add_u32 s67, s67, 65408
    s_cmp_eq_u32 s64, s48
    s_cselect_b32 s83, s83, 0
    s_cselect_b32 s87, s66, s67
    s_cselect_b32 s88, 8, 7
    v_rcp_f32 v214, v214
    v_rcp_f32 v232, v232
    v_pk_mul_f32 v[210:211], v[210:211], v[214:215] op_sel_hi:[1,0]
    v_pk_mul_f32 v[228:229], v[228:229], v[232:233] op_sel_hi:[1,0]
    v_pk_mul_f32 v[212:213], v[212:213], v[214:215] op_sel_hi:[1,0]
    v_pk_mul_f32 v[230:231], v[230:231], v[232:233] op_sel_hi:[1,0]
    v_cvt_pk_bf16_f32 v236, v210, v211
    v_cvt_pk_bf16_f32 v238, v228, v229
    v_cvt_pk_bf16_f32 v237, v212, v213
    v_cvt_pk_bf16_f32 v239, v230, v231
    v_permlane16_swap_b32 v236, v238
    s_nop 0
    v_permlane16_swap_b32 v237, v239
    s_cmp_eq_u32 s50, 1
    s_cbranch_scc0 L_slow_17
    buffer_store_dwordx4 v[236:239], v254, s[40:43], 0 offen
L_join_18:
    s_lshl_b32 s68, s83, 1
    s_set_gpr_idx_on s68, gpr_idx(SRC0)
    v_mov_b32 v190, v130
    v_mov_b32 v191, v131
    v_mov_b32 v192, v132
    v_mov_b32 v193, v133
    v_mov_b32 v194, v134
    v_mov_b32 v195, v135
    v_mov_b32 v196, v122
    v_mov_b32 v197, v123
    v_mov_b32 v198, v124
    v_mov_b32 v199, v125
    v_mov_b32 v156, v140
    v_mov_b32 v157, v141
    v_mov_b32 v158, v142
    v_mov_b32 v159, v143
    v_mov_b32 v160, v144
    v_mov_b32 v161, v145
    s_set_gpr_idx_off
    s_set_gpr_idx_on s83, gpr_idx(SRC0)
    v_mov_b32 v162, v151
    v_mov_b32 v163, v152
    s_set_gpr_idx_off
    s_cmp_eq_u32 s83, 1
    s_cselect_b64 vcc, -1, 0
    v_cndmask_b32 v164, v22, v30, vcc
    v_cndmask_b32 v165, v23, v31, vcc
    v_cndmask_b32 v166, v24, v32, vcc
    v_cndmask_b32 v167, v25, v33, vcc
    s_mov_b32 s3, 393216
    buffer_load_dwordx4 a[216:219], v240, s[16:19], s3 offen sc1
    s_lshl_b32 s68, s47, 4
    s_lshl_b32 s69, s78, 3
    s_sub_u32 s68, s68, s69
    v_add_u32 v124, s68, v1
    v_and_b32 v124, 63, v124
    v_lshlrev_b32 v125, s88, v124
    v_and_b32 v126, 1, v2
    v_lshlrev_b32 v126, 3, v126
    v_add3_u32 v125, v125, v126, s87
    s_mov_b32 s3, 458752
    buffer_load_dwordx4 a[220:223], v240, s[16:19], s3 offen sc1
    v_lshl_add_u32 v124, v124, 4, v126
    v_add_u32 v124, 156672, v124
    s_lshl_b32 s68, s83, 4
    s_add_u32 s68, s68, s84
    s_lshl_b32 s68, s68, 2
    s_add_u32 s68, s68, 147520
    v_mov_b32 v128, s68
    ds_read_b64 v[126:127], v125
    ds_read2_b32 v[148:149], v128 offset0:0 offset1:160
    s_mov_b32 s3, 1024
    buffer_load_dwordx4 v[168:171], v240, s[16:19], s3 offen sc1
    v_mov_b32 v132, 0x3F80
    v_mov_b32 v133, 0
    v_and_b32 v150, 48, v3
    s_mov_b32 vcc_lo, 0xF0F0F0F0
    s_mov_b32 vcc_hi, 0xF0F0F0F0
    v_lshlrev_b64 v[132:133], v150, v[132:133]
    v_cndmask_b32 v134, 0, v132, vcc
    v_cndmask_b32 v135, 0, v133, vcc
    v_cndmask_b32 v132, v132, 0, vcc
    s_mov_b32 s3, 66560
    buffer_load_dwordx4 v[172:175], v240, s[16:19], s3 offen sc1
    v_cndmask_b32 v133, v133, 0, vcc
    s_and_b32 s68, s82, 0xFFFFF800
    s_ashr_i32 s69, s68, 31
    s_not_b32 s69, s69
    s_or_b32 s69, s69, 0x80000000
    s_xor_b32 s68, s68, s69
    v_mov_b32 v138, 0xBFB8AA3B
    v_mul_f32 v138, s68, v138
    v_exp_f32 v138, v138
    s_mov_b32 s3, 132096
    buffer_load_dwordx4 v[176:179], v241, s[16:19], s3 offen sc1
    s_nop 0
    v_add_f32 v138, 1.0, v138
    v_rcp_f32 v138, v138
    v_mov_b32 v142, 2147418112
    v_lshlrev_b32 v143, 4, v2
    v_add_u32 v143, 156672, v143
    s_waitcnt lgkmcnt(0)
    v_mul_f32 v148, v148, v149
    v_add_f32 v149, 1.0, v149
    v_lshlrev_b32 v128, 16, v126
    v_and_b32 v129, 0xFFFF0000, v126
    v_pk_fma_f32 v[128:129], v[128:129], v[148:149], v[148:149] op_sel:[0,1,0] op_sel_hi:[1,1,0]
    v_lshlrev_b32 v130, 16, v127
    v_and_b32 v131, 0xFFFF0000, v127
    v_pk_fma_f32 v[130:131], v[130:131], v[148:149], v[148:149] op_sel:[0,1,0] op_sel_hi:[1,1,0]
    v_and_b32 v148, 1, v2
    s_sub_u32 s68, s83, 1
    v_add_u32 v148, s68, v148
    s_lshl_b32 s68, s68, 14
    v_cmp_gt_u32 vcc, 4, v148
    v_add_u32 v148, s68, v12
    s_add_u32 s68, s47, 1
    v_cndmask_b32 v142, v142, v148, vcc
    s_cmp_eq_u32 s68, s83
    s_cselect_b32 s68, s84, 99
    v_cmp_eq_u32 vcc, s68, v1
    s_bfe_u32 s69, s85, 0x3000B
    s_lshl_b32 s69, s69, 7
    s_add_u32 s69, s69, 156672
    v_lshl_add_u32 v148, v2, 3, s69
    v_cndmask_b32 v20, v20, 1.0, vcc
    v_cndmask_b32 v21, v21, 0, vcc
    v_cndmask_b32 v248, v248, v148, vcc
    v_add_u32 v148, 32, v148
    v_cndmask_b32 v249, v249, v148, vcc
    v_add_u32 v148, 32, v148
    v_cndmask_b32 v250, v250, v148, vcc
    v_add_u32 v148, 32, v148
    v_cndmask_b32 v251, v251, v148, vcc
    v_add_u32 v148, 32, v148
    s_and_b32 s68, s84, 1
    s_lshl_b32 s68, s68, 4
    s_lshl_b32 s68, 0xFFFF, s68
    s_lshr_b32 s69, s84, 1
    v_lshlrev_b32 v148, 1, v2
    v_mov_b32 v149, s68
    v_cmp_eq_u32 vcc, s69, v148
    v_add_u32 v148, 1, v148
    v_cmp_eq_u32 s[70:71], s84, v1
    v_cndmask_b32 v140, 0, v149, vcc
    v_cmp_eq_u32 vcc, s69, v148
    s_nop 1
    v_cndmask_b32 v141, 0, v149, vcc
L_ypoll:
    s_waitcnt vmcnt(10)
    v_mfma_f32_16x16x32_bf16 v[144:147], v[132:135], a[192:195], 0
    s_waitcnt vmcnt(9)
    v_mfma_f32_16x16x32_bf16 v[144:147], v[132:135], a[196:199], v[144:147]
    s_waitcnt vmcnt(8)
    v_mfma_f32_16x16x32_bf16 v[144:147], v[132:135], a[200:203], v[144:147]
    s_waitcnt vmcnt(7)
    v_mfma_f32_16x16x32_bf16 v[144:147], v[132:135], a[204:207], v[144:147]
    s_waitcnt vmcnt(6)
    v_mfma_f32_16x16x32_bf16 v[144:147], v[132:135], a[208:211], v[144:147]
    s_waitcnt vmcnt(5)
    v_mfma_f32_16x16x32_bf16 v[144:147], v[132:135], a[212:215], v[144:147]
    s_waitcnt vmcnt(4)
    v_mfma_f32_16x16x32_bf16 v[144:147], v[132:135], a[216:219], v[144:147]
    s_waitcnt vmcnt(3)
    v_mfma_f32_16x16x32_bf16 v[144:147], v[132:135], a[220:223], v[144:147]
    s_waitcnt vmcnt(2)
    v_mfma_f32_16x16x32_bf16 v[144:147], v[132:135], v[168:171], v[144:147]
    s_waitcnt vmcnt(1)
    v_mfma_f32_16x16x32_bf16 v[144:147], v[132:135], v[172:175], v[144:147]
    s_waitcnt vmcnt(0)
    v_mfma_f32_16x16x32_bf16 v[144:147], v[132:135], v[176:179], v[144:147]
    s_nop 7
    v_cmp_u_f32 vcc, v144, v144
    s_cbranch_vccnz L_ypoll_r
    v_fma_f32 v128, v144, v138, v128
    v_fma_f32 v129, v145, v138, v129
    v_fma_f32 v130, v146, v138, v130
    v_fma_f32 v131, v147, v138, v131
    v_cvt_pk_bf16_f32 v126, v128, v129
    v_cvt_pk_bf16_f32 v127, v130, v131
    v_add_u32 v125, 156672, v3
    ds_write_b64 v124, v[126:127]
    s_waitcnt lgkmcnt(0)
    s_barrier
    ds_read_b128 v[200:203], v125
    ds_read_b128 a[192:195], v143 offset:0
    ds_read_b128 a[196:199], v143 offset:64
    ds_read_b128 a[200:203], v143 offset:128
    ds_read_b128 a[204:207], v143 offset:192
    ds_read_b128 a[208:211], v143 offset:256
    ds_read_b128 a[212:215], v143 offset:320
    s_waitcnt lgkmcnt(5)
    v_mfma_f32_16x16x32_bf16 v[172:175], a[4:7], a[192:195], 0
    ds_read_b128 a[216:219], v143 offset:384
    v_mfma_f32_16x16x32_bf16 v[168:171], a[0:3], a[192:195], 0
    v_lshlrev_b32 v204, 16, v200
    v_mfma_f32_16x16x32_bf16 v[176:179], a[192:195], a[8:11], 0
    v_and_b32 v205, 0xFFFF0000, v200
    s_waitcnt lgkmcnt(5)
    v_mfma_f32_16x16x32_bf16 v[172:175], a[16:19], a[196:199], v[172:175]
    ds_read_b128 a[220:223], v143 offset:448
    v_lshlrev_b32 v206, 16, v201
    v_mfma_f32_16x16x32_bf16 v[168:171], a[12:15], a[196:199], v[168:171]
    v_and_b32 v207, 0xFFFF0000, v201
    v_mfma_f32_16x16x32_bf16 v[176:179], a[196:199], a[20:23], v[176:179]
    v_lshlrev_b32 v208, 16, v202
    s_waitcnt lgkmcnt(4)
    v_mfma_f32_16x16x32_bf16 v[172:175], a[28:31], a[200:203], v[172:175]
    ds_read_b128 a[192:195], v143 offset:512
    v_and_b32 v209, 0xFFFF0000, v202
    v_mfma_f32_16x16x32_bf16 v[168:171], a[24:27], a[200:203], v[168:171]
    v_lshlrev_b32 v210, 16, v203
    v_mfma_f32_16x16x32_bf16 v[176:179], a[200:203], a[32:35], v[176:179]
    v_and_b32 v211, 0xFFFF0000, v203
    v_add_f32 v128, v204, v205
    v_mfma_f32_16x16x32_bf16 v[172:175], a[40:43], a[204:207], v[172:175]
    ds_read_b128 a[196:199], v143 offset:576
    v_mfma_f32_16x16x32_bf16 v[168:171], a[36:39], a[204:207], v[168:171]
    v_mul_f32 v129, v204, v204
    v_fmac_f32 v129, v205, v205
    v_mfma_f32_16x16x32_bf16 v[176:179], a[204:207], a[44:47], v[176:179]
    s_waitcnt lgkmcnt(4)
    v_mfma_f32_16x16x32_bf16 v[172:175], a[52:55], a[208:211], v[172:175]
    ds_read_b128 a[200:203], v143 offset:640
    v_add_f32 v128, v128, v206
    v_mfma_f32_16x16x32_bf16 v[168:171], a[48:51], a[208:211], v[168:171]
    v_fmac_f32 v129, v206, v206
    v_mfma_f32_16x16x32_bf16 v[176:179], a[208:211], a[56:59], v[176:179]
    v_add_f32 v128, v128, v207
    v_fmac_f32 v129, v207, v207
    v_mfma_f32_16x16x32_bf16 v[172:175], a[64:67], a[212:215], v[172:175]
    ds_read_b128 a[204:207], v143 offset:704
    v_mfma_f32_16x16x32_bf16 v[168:171], a[60:63], a[212:215], v[168:171]
    v_add_f32 v128, v128, v208
    v_fmac_f32 v129, v208, v208
    v_mfma_f32_16x16x32_bf16 v[176:179], a[212:215], a[68:71], v[176:179]
    v_add_f32 v128, v128, v209
    s_waitcnt lgkmcnt(4)
    v_mfma_f32_16x16x32_bf16 v[172:175], a[76:79], a[216:219], v[172:175]
    ds_read_b128 a[208:211], v143 offset:768
    v_mfma_f32_16x16x32_bf16 v[168:171], a[72:75], a[216:219], v[168:171]
    v_fmac_f32 v129, v209, v209
    v_add_f32 v128, v128, v210
    v_mfma_f32_16x16x32_bf16 v[176:179], a[216:219], a[80:83], v[176:179]
    v_fmac_f32 v129, v210, v210
    v_mfma_f32_16x16x32_bf16 v[172:175], a[88:91], a[220:223], v[172:175]
    ds_read_b128 a[212:215], v143 offset:832
    v_add_f32 v128, v128, v211
    v_mfma_f32_16x16x32_bf16 v[168:171], a[84:87], a[220:223], v[168:171]
    v_fmac_f32 v129, v211, v211
    v_mfma_f32_16x16x32_bf16 v[176:179], a[220:223], a[92:95], v[176:179]
    v_add_f32_dpp v128, v128, v128 row_ror:8 row_mask:0xf bank_mask:0xf
    s_waitcnt lgkmcnt(4)
    v_mfma_f32_16x16x32_bf16 v[172:175], a[100:103], a[192:195], v[172:175]
    ds_read_b128 a[216:219], v143 offset:896
    v_mfma_f32_16x16x32_bf16 v[168:171], a[96:99], a[192:195], v[168:171]
    v_add_f32_dpp v129, v129, v129 row_ror:8 row_mask:0xf bank_mask:0xf
    v_add_f32_dpp v128, v128, v128 row_ror:4 row_mask:0xf bank_mask:0xf
    v_mfma_f32_16x16x32_bf16 v[176:179], a[192:195], a[104:107], v[176:179]
    v_add_f32_dpp v129, v129, v129 row_ror:4 row_mask:0xf bank_mask:0xf
    v_mfma_f32_16x16x32_bf16 v[172:175], a[112:115], a[196:199], v[172:175]
    ds_read_b128 a[220:223], v143 offset:960
    v_add_f32_dpp v128, v128, v128 row_ror:2 row_mask:0xf bank_mask:0xf
    v_mfma_f32_16x16x32_bf16 v[168:171], a[108:111], a[196:199], v[168:171]
    v_add_f32_dpp v129, v129, v129 row_ror:2 row_mask:0xf bank_mask:0xf
    v_mfma_f32_16x16x32_bf16 v[176:179], a[196:199], a[116:119], v[176:179]
    v_add_f32_dpp v128, v128, v128 row_ror:1 row_mask:0xf bank_mask:0xf
    s_waitcnt lgkmcnt(4)
    v_mfma_f32_16x16x32_bf16 v[172:175], a[124:127], a[200:203], v[172:175]
    v_add_f32_dpp v129, v129, v129 row_ror:1 row_mask:0xf bank_mask:0xf
    v_mfma_f32_16x16x32_bf16 v[168:171], a[120:123], a[200:203], v[168:171]
    s_nop 0
    v_permlane32_swap_b32 v128, v129
    v_add_f32 v200, v128, v129
    v_mfma_f32_16x16x32_bf16 v[176:179], a[200:203], a[128:131], v[176:179]
    v_add_f32 v201, v128, v129
    v_mfma_f32_16x16x32_bf16 v[172:175], a[136:139], a[204:207], v[172:175]
    s_nop 0
    v_permlane16_swap_b32 v200, v201
    v_add_f32 v128, v200, v201
    v_mfma_f32_16x16x32_bf16 v[168:171], a[132:135], a[204:207], v[168:171]
    v_add_f32 v129, v200, v201
    v_mfma_f32_16x16x32_bf16 v[176:179], a[204:207], a[140:143], v[176:179]
    s_nop 0
    v_permlane32_swap_b32 v128, v129
    s_waitcnt lgkmcnt(2)
    v_mfma_f32_16x16x32_bf16 v[172:175], a[148:151], a[208:211], v[172:175]
    v_mul_f32 v128, 0xBB000000, v128
    v_mfma_f32_16x16x32_bf16 v[168:171], a[144:147], a[208:211], v[168:171]
    v_mul_f32 v129, 0x3B000000, v129
    v_mfma_f32_16x16x32_bf16 v[176:179], a[208:211], a[152:155], v[176:179]
    v_fma_f32 v129, -v128, v128, v129
    v_max_f32 v129, 0, v129
    v_mfma_f32_16x16x32_bf16 v[172:175], a[160:163], a[212:215], v[172:175]
    v_add_f32 v129, 925353388, v129
    v_mfma_f32_16x16x32_bf16 v[168:171], a[156:159], a[212:215], v[168:171]
    v_rsq_f32 v129, v129
    v_mfma_f32_16x16x32_bf16 v[176:179], a[212:215], a[164:167], v[176:179]
    s_waitcnt lgkmcnt(0)
    v_mfma_f32_16x16x32_bf16 v[172:175], a[172:175], a[216:219], v[172:175]
    v_mul_f32 v200, 0x3EB8AA3B, v129
    v_cndmask_b32 v162, v162, v200, s[70:71]
    v_mfma_f32_16x16x32_bf16 v[168:171], a[168:171], a[216:219], v[168:171]
    v_mfma_f32_16x16x32_bf16 v[176:179], a[216:219], a[176:179], v[176:179]
    v_mfma_f32_16x16x32_bf16 v[172:175], a[184:187], a[220:223], v[172:175]
    v_mfma_f32_16x16x32_bf16 v[168:171], a[180:183], a[220:223], v[168:171]
    v_mfma_f32_16x16x32_bf16 v[176:179], a[220:223], a[188:191], v[176:179]
    v_mfma_f32_16x16x16_bf16 v[224:227], v[194:195], v[198:199], v[26:29]
    s_nop 4
    v_pk_fma_f32 v[172:173], v[44:45], v[128:129], v[172:173] op_sel_hi:[1,0,1]
    v_pk_fma_f32 v[174:175], v[46:47], v[128:129], v[174:175] op_sel_hi:[1,0,1]
    v_pk_fma_f32 v[168:169], v[40:41], v[128:129], v[168:169] op_sel_hi:[1,0,1]
    v_pk_fma_f32 v[170:171], v[42:43], v[128:129], v[170:171] op_sel_hi:[1,0,1]
    v_pk_mul_f32 v[172:173], v[172:173], v[128:129] op_sel:[0,1] op_sel_hi:[1,1]
    v_pk_mul_f32 v[174:175], v[174:175], v[128:129] op_sel:[0,1] op_sel_hi:[1,1]
    v_cvt_pk_bf16_f32 v168, v168, v169
    v_cvt_pk_bf16_f32 v172, v172, v173
    v_cvt_pk_bf16_f32 v169, v170, v171
    v_cvt_pk_bf16_f32 v173, v174, v175
    v_cndmask_b32 v196, v196, v168, s[70:71]
    v_cndmask_b32 v192, v192, v172, s[70:71]
    v_cndmask_b32 v197, v197, v169, s[70:71]
    v_cndmask_b32 v193, v193, v173, s[70:71]
    v_fmac_f32 v176, v128, v48
    v_mul_f32 v176, v176, v129
    v_mfma_f32_16x16x16_bf16 v[202:205], v[190:191], v[196:197], v[164:167]
    v_mfma_f32_16x16x16_bf16 v[206:209], v[192:193], v[196:197], v[26:29]
    v_mfma_f32_16x16x16_bf16 v[220:223], v[192:193], v[198:199], v[22:25]
    v_cvt_pk_bf16_f32 v176, v176, v176
    v_bfi_b32 v158, v140, v176, v158
    v_bfi_b32 v159, v141, v176, v159
    s_nop 3
    v_max_f32 v202, v202, v206
    v_max_f32 v203, v203, v207
    v_max_f32 v204, v204, v208
    v_max_f32 v205, v205, v209
    v_max3_f32 v200, v202, v203, v204
    v_max_f32 v200, v200, v205
    v_max_f32 v220, v220, v224
    v_max_f32 v221, v221, v225
    v_max_f32 v222, v222, v226
    v_max_f32 v223, v223, v227
    v_max3_f32 v218, v220, v221, v222
    v_max_f32 v218, v218, v223
    s_nop 1
    v_permlane32_swap_b32 v200, v218
    v_max_f32 v201, v200, v218
    v_max_f32 v219, v200, v218
    s_nop 1
    v_permlane16_swap_b32 v201, v219
    v_max_f32 v200, v201, v219
    v_max_f32 v218, v201, v219
    s_nop 1
    v_permlane32_swap_b32 v200, v218
    v_mul_f32 v200, v200, v162
    v_mul_f32 v218, v218, v163
    v_pk_fma_f32 v[202:203], v[202:203], v[162:163], v[200:201] op_sel:[0,0,0] op_sel_hi:[1,0,0] neg_lo:[0,0,1] neg_hi:[0,0,1]
    v_pk_fma_f32 v[220:221], v[220:221], v[162:163], v[218:219] op_sel:[0,1,0] op_sel_hi:[1,1,0] neg_lo:[0,0,1] neg_hi:[0,0,1]
    v_pk_fma_f32 v[204:205], v[204:205], v[162:163], v[200:201] op_sel:[0,0,0] op_sel_hi:[1,0,0] neg_lo:[0,0,1] neg_hi:[0,0,1]
    v_pk_fma_f32 v[222:223], v[222:223], v[162:163], v[218:219] op_sel:[0,1,0] op_sel_hi:[1,1,0] neg_lo:[0,0,1] neg_hi:[0,0,1]
    v_exp_f32 v202, v202
    v_exp_f32 v220, v220
    v_exp_f32 v203, v203
    v_exp_f32 v221, v221
    v_exp_f32 v204, v204
    v_exp_f32 v222, v222
    v_exp_f32 v205, v205
    v_exp_f32 v223, v223
    v_cvt_pk_bf16_f32 v200, v202, v203
    v_cvt_pk_bf16_f32 v218, v220, v221
    v_cvt_pk_bf16_f32 v201, v204, v205
    v_cvt_pk_bf16_f32 v219, v222, v223
    v_and_b32 v206, v34, v200
    v_and_b32 v224, v34, v218
    v_and_b32 v207, v35, v201
    v_and_b32 v225, v35, v219
    v_bfi_b32 v208, v34, 0, v200
    v_bfi_b32 v226, v34, 0, v218
    v_bfi_b32 v209, v35, 0, v201
    v_bfi_b32 v227, v35, 0, v219
    v_mfma_f32_16x16x16_bf16 v[214:217], v[36:37], v[200:201], 0
    v_mfma_f32_16x16x32_bf16 v[210:213], v[156:159], v[206:209], 0
    v_mfma_f32_16x16x16_bf16 v[232:235], v[36:37], v[218:219], 0
    v_mfma_f32_16x16x32_bf16 v[228:231], v[158:161], v[224:227], 0
    s_nop 4
    v_rcp_f32 v214, v214
    s_nop 0
    v_rcp_f32 v232, v232
    v_pk_mul_f32 v[210:211], v[210:211], v[214:215] op_sel_hi:[1,0]
    v_pk_mul_f32 v[228:229], v[228:229], v[232:233] op_sel_hi:[1,0]
    v_pk_mul_f32 v[212:213], v[212:213], v[214:215] op_sel_hi:[1,0]
    v_pk_mul_f32 v[230:231], v[230:231], v[232:233] op_sel_hi:[1,0]
    v_cvt_pk_bf16_f32 v236, v210, v211
    v_cvt_pk_bf16_f32 v238, v228, v229
    v_cvt_pk_bf16_f32 v237, v212, v213
    v_cvt_pk_bf16_f32 v239, v230, v231
    v_permlane16_swap_b32 v236, v238
    s_nop 0
    v_permlane16_swap_b32 v237, v239
    s_cmp_eq_u32 s50, 1
    s_cbranch_scc0 L_slow_19
    buffer_store_dwordx4 v[236:239], v142, s[40:43], 0 offen
L_join_20:
    s_branch L_oh
L_final:
    v_pk_fma_f32 v[156:157], v[132:133], v[218:219], v[20:21] op_sel:[0,0,1] op_sel_hi:[1,0,1]
    v_pk_fma_f32 v[158:159], v[134:135], v[218:219], v[20:21] op_sel:[0,0,1] op_sel_hi:[1,0,1]
    v_pk_fma_f32 v[160:161], v[136:137], v[218:219], v[20:21] op_sel:[0,0,1] op_sel_hi:[1,0,1]
    v_pk_fma_f32 v[162:163], v[138:139], v[218:219], v[20:21] op_sel:[0,0,1] op_sel_hi:[1,0,1]
    v_pk_fma_f32 v[164:165], v[140:141], v[218:219], v[20:21] op_sel:[0,0,1] op_sel_hi:[1,0,1]
    v_pk_fma_f32 v[166:167], v[142:143], v[218:219], v[20:21] op_sel:[0,0,1] op_sel_hi:[1,0,1]
    v_pk_fma_f32 v[168:169], v[144:145], v[218:219], v[20:21] op_sel:[0,0,1] op_sel_hi:[1,0,1]
    v_pk_fma_f32 v[170:171], v[146:147], v[218:219], v[20:21] op_sel:[0,0,1] op_sel_hi:[1,0,1]
    v_cmp_eq_u32 vcc, v220, v223
    s_lshl_b32 s68, s45, 7
    s_add_u32 s67, s67, s68
    v_cvt_pk_bf16_f32 v148, v156, v157
    v_cvt_pk_bf16_f32 v149, v158, v159
    v_cvt_pk_bf16_f32 v150, v160, v161
    v_cvt_pk_bf16_f32 v151, v162, v163
    v_cvt_pk_bf16_f32 v152, v164, v165
    v_cvt_pk_bf16_f32 v153, v166, v167
    v_cvt_pk_bf16_f32 v154, v168, v169
    v_cvt_pk_bf16_f32 v155, v170, v171
    s_mov_b64 s[70:71], vcc
    s_and_b64 exec, exec, vcc
    s_cbranch_execz L_norow
    buffer_store_dwordx4 v[148:151], v222, s[16:19], s67 offen sc1
    buffer_store_dwordx4 v[152:155], v222, s[16:19], s67 offen offset:64 sc1
L_norow:
    s_mov_b64 exec, -1
    v_pk_add_f32 v[132:133], v[132:133], v[156:157]
    v_pk_add_f32 v[134:135], v[134:135], v[158:159]
    v_pk_add_f32 v[136:137], v[136:137], v[160:161]
    v_pk_add_f32 v[138:139], v[138:139], v[162:163]
    v_pk_add_f32 v[140:141], v[140:141], v[164:165]
    v_pk_add_f32 v[142:143], v[142:143], v[166:167]
    v_pk_add_f32 v[144:145], v[144:145], v[168:169]
    v_pk_add_f32 v[146:147], v[146:147], v[170:171]
    v_lshlrev_b32 v223, 1, v222
    v_add_u32 v223, 156672, v223
    s_mov_b64 exec, vcc
    ds_write_b128 v223, v[132:135] offset:0
    ds_write_b128 v223, v[136:139] offset:16
    ds_write_b128 v223, v[140:143] offset:128
    ds_write_b128 v223, v[144:147] offset:144
    s_mov_b64 exec, -1
    v_mov_b32 v188, v222
    s_add_u32 s80, s80, s68
    s_cmp_lt_u32 s51, 43
    s_cbranch_scc1 L_ffn
L_ffn_done:
    v_cvt_pk_bf16_f32 v172, v132, v133
    v_cvt_pk_bf16_f32 v173, v134, v135
    v_cvt_pk_bf16_f32 v174, v136, v137
    v_cvt_pk_bf16_f32 v175, v138, v139
    v_cvt_pk_bf16_f32 v176, v140, v141
    v_cvt_pk_bf16_f32 v177, v142, v143
    v_cvt_pk_bf16_f32 v178, v144, v145
    v_cvt_pk_bf16_f32 v179, v146, v147
    v_and_b32 v223, 7, v1
    v_lshlrev_b32 v223, 4, v223
    v_xor_b32 v223, v223, v188
    v_lshl_add_u32 v223, v1, 7, v223
    v_add_u32 v223, s79, v223
    v_xor_b32 v225, 64, v223
    v_add_u32 v224, s79, v3
    ds_write_b128 v223, v[172:175]
    ds_write_b128 v225, v[176:179]
    ds_read_b128 v[180:183], v224
    ds_read_b128 v[184:187], v224 offset:1024
    s_lshl_b32 s65, s47, 15
    s_add_u32 s64, s80, s65
    s_add_u32 s65, s64, 16384
    v_lshrrev_b32 v223, 3, v0
    v_and_b32 v224, 7, v0
    v_xor_b32 v224, v224, v223
    v_lshlrev_b32 v224, 4, v224
    v_lshl_add_u32 v223, v223, 11, v224
    s_waitcnt lgkmcnt(0)
    buffer_store_dwordx4 v[180:183], v223, s[20:23], s64 offen sc1
    buffer_store_dwordx4 v[184:187], v223, s[20:23], s65 offen sc1
    s_add_u32 s64, s2, s47
    s_cmp_eq_u32 s64, 0
    s_cbranch_scc0 L_noepoch
    v_mov_b32 v196, s49
    s_mov_b64 exec, 1
    buffer_store_dword v196, v0, s[16:19], 0 offen sc1
    s_mov_b64 exec, -1
L_noepoch:
    s_cmp_eq_u64 s[70:71], 0
    s_cbranch_scc1 L_exit
    v_lshlrev_b32 v198, 7, v0
    v_mov_b32 v196, 0
    s_lshl_b32 s67, s55, 12
    s_add_u32 s67, s67, 196608
    s_mul_i32 s69, s55, 3
    s_add_u32 s69, s69, s49
    s_add_u32 s69, s69, 2
    s_mov_b32 exec_hi, 0
L_bpoll3:
    buffer_load_dwordx2 v[196:197], v198, s[16:19], s67 offen sc1
    s_sub_u32 s53, s53, 1
    s_cbranch_scc1 L_exit
    s_waitcnt vmcnt(0)
    v_cmp_ne_u32 vcc, s69, v197
    s_and_b64 exec, exec, vcc
    s_cbranch_scc0 L_pd_21
    s_sleep 6
    s_branch L_bpoll3
L_pd_21:
    s_mov_b64 exec, -1
    v_max_u32_dpp v199, v196, v196 row_ror:8 row_mask:0xf bank_mask:0xf
    s_nop 1
    v_max_u32_dpp v199, v199, v199 row_ror:4 row_mask:0xf bank_mask:0xf
    s_nop 1
    v_max_u32_dpp v199, v199, v199 row_ror:2 row_mask:0xf bank_mask:0xf
    s_nop 1
    v_max_u32_dpp v199, v199, v199 row_ror:1 row_mask:0xf bank_mask:0xf
    s_nop 0
    v_readlane_b32 s66, v199, 0
    v_readlane_b32 s82, v199, 16
    s_max_u32 s82, s66, s82
    s_bfe_u32 s64, s82, 0x70004
    s_lshl_b32 s65, s48, 2
    s_add_u32 s65, s65, s47
    s_cmp_eq_u32 s64, s65
    s_cbranch_scc0 L_exit
    v_mov_b32 v132, 0x3F80
    v_mov_b32 v133, 0
    v_and_b32 v240, 48, v3
    s_mov_b32 vcc_lo, 0xF0F0F0F0
    s_mov_b32 vcc_hi, 0xF0F0F0F0
    v_lshlrev_b64 v[132:133], v240, v[132:133]
    v_cndmask_b32 v134, 0, v132, vcc
    v_cndmask_b32 v135, 0, v133, vcc
    v_cndmask_b32 v132, v132, 0, vcc
    v_cndmask_b32 v133, v133, 0, vcc
    s_and_b32 s68, s82, 0xFFFFF800
    s_ashr_i32 s69, s68, 31
    s_not_b32 s69, s69
    s_or_b32 s69, s69, 0x80000000
    s_xor_b32 s68, s68, s69
    v_mov_b32 v138, 0xBFB8AA3B
    v_mul_f32 v138, s68, v138
    v_exp_f32 v138, v138
    s_nop 0
    v_add_f32 v138, 1.0, v138
    v_rcp_f32 v138, v138
    v_lshrrev_b32 v124, 3, v0
    v_and_b32 v125, 7, v0
    v_lshlrev_b32 v240, 4, v125
    v_lshl_add_u32 v240, v124, 14, v240
    s_lshl_b32 s68, s45, 7
    s_add_u32 s68, s68, 536576
    v_add_u32 v240, s68, v240
    v_mov_b32 v241, 2147418112
    v_cmp_gt_u32 vcc, 3, v124
    s_nop 1
    v_cndmask_b32 v241, v241, v240, vcc
    v_and_b32 v124, 1, v2
    v_lshl_add_u32 v124, v125, 1, v124
    v_lshlrev_b32 v125, 4, v124
    v_add_u32 v125, 156672, v125
    ds_read_b128 v[128:131], v125
    v_lshlrev_b32 v124, 3, v124
    s_and_b32 s64, s82, 63
    s_lshl_b32 s64, s64, 11
    s_add_u32 s64, s64, s80
    s_mov_b32 s3, 0
    buffer_load_dwordx4 a[192:195], v240, s[16:19], s3 offen sc1
    s_mov_b32 s3, 131072
    buffer_load_dwordx4 a[196:199], v240, s[16:19], s3 offen sc1
    s_mov_b32 s3, 262144
    buffer_load_dwordx4 a[200:203], v240, s[16:19], s3 offen sc1
    s_mov_b32 s3, 393216
    buffer_load_dwordx4 a[204:207], v240, s[16:19], s3 offen sc1
    s_mov_b32 s3, 1024
    buffer_load_dwordx4 a[208:211], v240, s[16:19], s3 offen sc1
    s_mov_b32 s3, 132096
    buffer_load_dwordx4 a[212:215], v241, s[16:19], s3 offen sc1
L_zpoll:
    s_waitcnt vmcnt(5)
    v_mfma_f32_16x16x32_bf16 v[144:147], v[132:135], a[192:195], 0
    s_waitcnt vmcnt(4)
    v_mfma_f32_16x16x32_bf16 v[144:147], v[132:135], a[196:199], v[144:147]
    s_waitcnt vmcnt(3)
    v_mfma_f32_16x16x32_bf16 v[144:147], v[132:135], a[200:203], v[144:147]
    s_waitcnt vmcnt(2)
    v_mfma_f32_16x16x32_bf16 v[144:147], v[132:135], a[204:207], v[144:147]
    s_waitcnt vmcnt(1)
    v_mfma_f32_16x16x32_bf16 v[144:147], v[132:135], a[208:211], v[144:147]
    s_waitcnt vmcnt(0)
    v_mfma_f32_16x16x32_bf16 v[144:147], v[132:135], a[212:215], v[144:147]
    s_nop 7
    v_cmp_u_f32 vcc, v144, v144
    s_cbranch_vccnz L_zpoll_r
    s_waitcnt lgkmcnt(0)
    v_add_f32_dpp v144, v144, v144 row_ror:8 row_mask:0xf bank_mask:0xf
    v_add_f32_dpp v145, v145, v145 row_ror:8 row_mask:0xf bank_mask:0xf
    v_add_f32_dpp v146, v146, v146 row_ror:8 row_mask:0xf bank_mask:0xf
    v_add_f32_dpp v147, v147, v147 row_ror:8 row_mask:0xf bank_mask:0xf
    v_fma_f32 v128, v144, v138, v128
    v_fma_f32 v129, v145, v138, v129
    v_fma_f32 v130, v146, v138, v130
    v_fma_f32 v131, v147, v138, v131
    v_cvt_pk_bf16_f32 v126, v128, v129
    v_cvt_pk_bf16_f32 v127, v130, v131
    s_mov_b64 exec, 0x00FF00FF
    buffer_store_dwordx2 v[126:127], v124, s[20:23], s64 offen sc1
    s_mov_b64 exec, -1
L_exit:
L_end:
    s_endpgm
L_slow_1:
    buffer_store_dwordx4 v[124:127], v12, s[40:43], 0 offen sc1
    s_branch L_join_2
L_slow_3:
    buffer_store_dwordx4 v[128:131], v12, s[40:43], s65 offen sc1
    s_branch L_join_4
L_slow_5:
    buffer_store_dword v205, v204, s[40:43], s64 offen sc1
    s_branch L_join_6
L_oslow:
    s_mov_b32 exec_lo, vcc_lo
    s_mov_b32 exec_hi, vcc_hi
L_opoll:
    buffer_load_dword v207, v206, s[40:43], s64 offen sc1
    s_sub_u32 s53, s53, 1
    s_cbranch_scc1 L_exit
    s_waitcnt vmcnt(0)
    v_cmp_ne_u32 vcc, s66, v207
    s_and_b64 exec, exec, vcc
    s_cbranch_scc1 L_opoll
    s_mov_b64 exec, -1
    s_branch L_ook
L_slow_7:
    buffer_store_dwordx4 v[196:199], v15, s[40:43], 0 offen sc1
    s_branch L_join_8
L_slow_9:
    buffer_store_dwordx4 v[124:127], v14, s[40:43], 0 offen sc1
    buffer_store_dwordx4 v[128:131], v14, s[40:43], 0 offen offset:1024 sc1
    s_branch L_join_10
L_slow_11:
    buffer_store_dword v205, v204, s[40:43], s64 offen offset:16 sc1
    s_branch L_join_12
L_xslow:
    buffer_load_dword v207, v206, s[40:43], s64 offen offset:16 sc1
    s_sub_u32 s53, s53, 1
    s_cbranch_scc1 L_exit
    s_waitcnt vmcnt(0)
    v_cmp_ne_u32 vcc, s68, v207
    s_cbranch_vccnz L_xslow
    s_branch L_xok
L_pub1:
    s_and_b32 s68, s82, 15
    s_lshl_b32 s69, s68, 4
    s_add_u32 s69, s69, s79
    s_add_u32 s69, s69, 131072
    v_lshlrev_b32 v200, 8, v0
    s_bfe_u32 s65, s82, 0x20004
    s_cmp_eq_u32 s65, s47
    s_cselect_b32 s65, 0, 2147418112
    v_or_b32 v200, s65, v200
    buffer_load_dwordx4 v[236:239], v200, s[40:43], s69 offen sc1
    v_lshrrev_b32 v200, 3, v0
    v_lshl_add_u32 v200, v200, 8, v209
    s_add_u32 s69, s87, 180352
    buffer_load_dwordx4 v[228:231], v200, s[40:43], s69 offen sc1
    buffer_load_dwordx4 v[232:235], v200, s[40:43], s69 offen offset:2048 sc1
    v_readlane_b32 s69, v21, s68
    v_readlane_b32 s68, v218, s68
    s_branch L_pubr
L_pub3:
    v_mov_b32 v200, s69
    v_or_b32 v201, s65, v3
    s_waitcnt vmcnt(8)
    v_lshlrev_b32 v202, 16, v236
    v_and_b32 v203, 0xFFFF0000, v236
    v_fma_f32 v202, v202, s68, v200
    v_fma_f32 v203, v203, s68, v200
    v_cvt_pk_bf16_f32 v236, v202, v203
    v_lshlrev_b32 v202, 16, v237
    v_and_b32 v203, 0xFFFF0000, v237
    v_fma_f32 v202, v202, s68, v200
    v_fma_f32 v203, v203, s68, v200
    v_cvt_pk_bf16_f32 v237, v202, v203
    v_lshlrev_b32 v202, 16, v238
    v_and_b32 v203, 0xFFFF0000, v238
    v_fma_f32 v202, v202, s68, v200
    v_fma_f32 v203, v203, s68, v200
    v_cvt_pk_bf16_f32 v238, v202, v203
    v_lshlrev_b32 v202, 16, v239
    v_and_b32 v203, 0xFFFF0000, v239
    v_fma_f32 v202, v202, s68, v200
    v_fma_f32 v203, v203, s68, v200
    v_cvt_pk_bf16_f32 v239, v202, v203
    buffer_store_dwordx4 v[236:239], v201, s[16:19], s67 offen sc1
    s_lshl_b32 s68, s47, 11
    s_add_u32 s68, s68, s67
    s_sub_u32 s68, s68, 8192
    buffer_store_dwordx4 v[228:231], v3, s[16:19], s68 offen sc1
    buffer_store_dwordx4 v[232:235], v3, s[16:19], s68 offen offset:1024 sc1
    s_cmp_eq_u32 s47, 3
    s_cselect_b32 s65, 0, 2147418112
    v_or_b32 v201, s65, v209
    s_lshl_b32 s68, s48, 7
    s_add_u32 s68, s68, 131072
    s_mov_b64 exec, 0xFF00
    buffer_store_dwordx4 v[216:219], v201, s[16:19], s68 offen sc1
    s_mov_b64 exec, -1
    s_waitcnt vmcnt(4) lgkmcnt(0)
    s_branch L_pubs
L_slow_ffn0:
    s_lshl_b32 s67, s47, 8
    s_lshl_b32 s69, s51, 15
    s_add_u32 s67, s67, s69
    s_add_u32 s69, s67, 16384
    v_lshlrev_b32 v201, 12, v2
    v_lshl_add_u32 v201, v1, 4, v201
    v_xor_b32 v200, 32, v123
    buffer_load_dwordx4 v[148:151], v201, s[32:35], s67 offen offset:0
    ds_read_b64_tr_b16 v[66:67], v123 offset:32768
    ds_read_b64_tr_b16 v[68:69], v123 offset:33024
    buffer_load_dwordx4 v[152:155], v201, s[32:35], s69 offen offset:0
    ds_read_b64_tr_b16 v[70:71], v200 offset:32768
    ds_read_b64_tr_b16 v[72:73], v200 offset:33024
    buffer_load_dwordx4 v[156:159], v201, s[32:35], s67 offen offset:1024
    ds_read_b64_tr_b16 v[82:83], v123 offset:34816
    ds_read_b64_tr_b16 v[84:85], v123 offset:35072
    buffer_load_dwordx4 v[160:163], v201, s[32:35], s69 offen offset:1024
    ds_read_b64_tr_b16 v[86:87], v200 offset:34816
    ds_read_b64_tr_b16 v[88:89], v200 offset:35072
    buffer_load_dwordx4 v[164:167], v201, s[32:35], s67 offen offset:2048
    ds_read_b64_tr_b16 v[98:99], v123 offset:36864
    ds_read_b64_tr_b16 v[100:101], v123 offset:37120
    buffer_load_dwordx4 v[168:171], v201, s[32:35], s69 offen offset:2048
    ds_read_b64_tr_b16 v[102:103], v200 offset:36864
    ds_read_b64_tr_b16 v[104:105], v200 offset:37120
    buffer_load_dwordx4 v[172:175], v201, s[32:35], s67 offen offset:3072
    ds_read_b64_tr_b16 v[114:115], v123 offset:38912
    ds_read_b64_tr_b16 v[116:117], v123 offset:39168
    buffer_load_dwordx4 v[176:179], v201, s[32:35], s69 offen offset:3072
    ds_read_b64_tr_b16 v[118:119], v200 offset:38912
    ds_read_b64_tr_b16 v[120:121], v200 offset:39168
    s_mov_b32 s68, 0x05040100
    s_mov_b32 s69, 0x07060302
    s_waitcnt lgkmcnt(0)
    s_barrier
    s_waitcnt vmcnt(6)
    v_perm_b32 v200, v152, v148, s68
    v_accvgpr_write_b32 a224, v200
    v_perm_b32 v201, v152, v148, s69
    v_accvgpr_write_b32 a228, v201
    v_perm_b32 v200, v153, v149, s68
    v_accvgpr_write_b32 a232, v200
    v_perm_b32 v201, v153, v149, s69
    v_accvgpr_write_b32 a236, v201
    v_perm_b32 v200, v154, v150, s68
    v_accvgpr_write_b32 a240, v200
    v_perm_b32 v201, v154, v150, s69
    v_accvgpr_write_b32 a244, v201
    v_perm_b32 v200, v155, v151, s68
    v_accvgpr_write_b32 a248, v200
    v_perm_b32 v201, v155, v151, s69
    v_accvgpr_write_b32 a252, v201
    s_waitcnt vmcnt(4)
    v_perm_b32 v200, v160, v156, s68
    v_accvgpr_write_b32 a225, v200
    v_perm_b32 v201, v160, v156, s69
    v_accvgpr_write_b32 a229, v201
    v_perm_b32 v200, v161, v157, s68
    v_accvgpr_write_b32 a233, v200
    v_perm_b32 v201, v161, v157, s69
    v_accvgpr_write_b32 a237, v201
    v_perm_b32 v200, v162, v158, s68
    v_accvgpr_write_b32 a241, v200
    v_perm_b32 v201, v162, v158, s69
    v_accvgpr_write_b32 a245, v201
    v_perm_b32 v200, v163, v159, s68
    v_accvgpr_write_b32 a249, v200
    v_perm_b32 v201, v163, v159, s69
    v_accvgpr_write_b32 a253, v201
    s_waitcnt vmcnt(2)
    v_perm_b32 v200, v168, v164, s68
    v_accvgpr_write_b32 a226, v200
    v_perm_b32 v201, v168, v164, s69
    v_accvgpr_write_b32 a230, v201
    v_perm_b32 v200, v169, v165, s68
    v_accvgpr_write_b32 a234, v200
    v_perm_b32 v201, v169, v165, s69
    v_accvgpr_write_b32 a238, v201
    v_perm_b32 v200, v170, v166, s68
    v_accvgpr_write_b32 a242, v200
    v_perm_b32 v201, v170, v166, s69
    v_accvgpr_write_b32 a246, v201
    v_perm_b32 v200, v171, v167, s68
    v_accvgpr_write_b32 a250, v200
    v_perm_b32 v201, v171, v167, s69
    v_accvgpr_write_b32 a254, v201
    s_waitcnt vmcnt(0)
    v_perm_b32 v200, v176, v172, s68
    v_accvgpr_write_b32 a227, v200
    v_perm_b32 v201, v176, v172, s69
    v_accvgpr_write_b32 a231, v201
    v_perm_b32 v200, v177, v173, s68
    v_accvgpr_write_b32 a235, v200
    v_perm_b32 v201, v177, v173, s69
    v_accvgpr_write_b32 a239, v201
    v_perm_b32 v200, v178, v174, s68
    v_accvgpr_write_b32 a243, v200
    v_perm_b32 v201, v178, v174, s69
    v_accvgpr_write_b32 a247, v201
    v_perm_b32 v200, v179, v175, s68
    v_accvgpr_write_b32 a251, v200
    v_perm_b32 v201, v179, v175, s69
    v_accvgpr_write_b32 a255, v201
L_ffn:
    v_lshlrev_b32 v244, 4, v2
    v_lshlrev_b32 v198, 7, v0
    v_mov_b32 v196, 0
    s_lshl_b32 s67, s55, 12
    s_add_u32 s67, s67, 196608
    s_mul_i32 s69, s55, 3
    s_add_u32 s69, s69, s49
    s_add_u32 s69, s69, 2
    s_mov_b32 exec_hi, 0
L_bpoll:
    buffer_load_dwordx2 v[196:197], v198, s[16:19], s67 offen sc1
    s_sub_u32 s53, s53, 1
    s_cbranch_scc1 L_exit
    s_waitcnt vmcnt(0)
    v_cmp_ne_u32 vcc, s69, v197
    s_and_b32 exec_lo, exec_lo, vcc_lo
    s_andn2_b32 s66, exec_lo, s90
    s_cbranch_scc1 L_bpoll
    s_mov_b32 s90, exec_lo
    v_mov_b32 v196, 0
    s_mov_b64 exec, -1
    s_nop 0
    v_max_u32_dpp v199, v196, v196 row_ror:8 row_mask:0xf bank_mask:0xf
    s_nop 1
    v_max_u32_dpp v199, v199, v199 row_ror:4 row_mask:0xf bank_mask:0xf
    s_nop 1
    v_max_u32_dpp v199, v199, v199 row_ror:2 row_mask:0xf bank_mask:0xf
    s_nop 1
    v_max_u32_dpp v199, v199, v199 row_ror:1 row_mask:0xf bank_mask:0xf
    s_nop 0
    v_readlane_b32 s66, v199, 0
    v_readlane_b32 s82, v199, 16
    s_max_u32 s82, s66, s82
L_rload:
    s_bfe_u32 s68, s82, 0x50006
    s_lshl4_add_u32 s68, s68, s55
    s_lshl2_add_u32 s68, s68, s47
    s_lshl_b32 s68, s68, 8
    s_add_u32 s68, s68, 532480
    buffer_load_dwordx4 v[200:203], v244, s[16:19], s68 offen offset:0 sc1
    buffer_load_dwordx4 v[204:207], v244, s[16:19], s68 offen offset:64 sc1
    buffer_load_dwordx4 v[208:211], v244, s[16:19], s68 offen offset:128 sc1
    buffer_load_dwordx4 v[212:215], v244, s[16:19], s68 offen offset:192 sc1
    s_cmp_eq_u32 s55, 0
    s_cbranch_scc1 L_join_t1
    s_cmp_eq_u32 s90, 0
    s_cbranch_scc1 L_slow_rchk
    s_mov_b32 exec_hi, 0
    s_mov_b32 exec_lo, s90
    s_mov_b32 s90, 0
L_bpollb:
    buffer_load_dwordx2 v[196:197], v198, s[16:19], s67 offen sc1
    s_sub_u32 s53, s53, 1
    s_cbranch_scc1 L_exit
    s_waitcnt vmcnt(0)
    v_cmp_ne_u32 vcc, s69, v197
    s_and_b64 exec, exec, vcc
    s_cbranch_scc1 L_bpollb
    s_mov_b64 exec, -1
    v_max_u32_dpp v199, v196, v196 row_ror:8 row_mask:0xf bank_mask:0xf
    s_nop 1
    v_max_u32_dpp v199, v199, v199 row_ror:4 row_mask:0xf bank_mask:0xf
    s_nop 1
    v_max_u32_dpp v199, v199, v199 row_ror:2 row_mask:0xf bank_mask:0xf
    s_nop 1
    v_max_u32_dpp v199, v199, v199 row_ror:1 row_mask:0xf bank_mask:0xf
    s_nop 0
    v_readlane_b32 s66, v199, 0
    v_readlane_b32 s65, v199, 16
    s_max_u32 s65, s66, s65
    s_cmp_eq_u32 s65, s82
    s_mov_b32 s82, s65
    s_cbranch_scc0 L_rload
L_slow_rchk:
    s_waitcnt vmcnt(0)
    v_mfma_f32_16x16x32_bf16 v[216:219], v[200:203], v[58:61], 0
    v_mfma_f32_16x16x32_bf16 v[220:223], v[200:203], v[62:65], 0
    v_mfma_f32_16x16x32_bf16 v[224:227], v[200:203], v[66:69], 0
    v_mfma_f32_16x16x32_bf16 v[228:231], v[200:203], v[70:73], 0
    v_mfma_f32_16x16x32_bf16 v[216:219], v[204:207], v[74:77], v[216:219]
    v_mfma_f32_16x16x32_bf16 v[220:223], v[204:207], v[78:81], v[220:223]
    v_mfma_f32_16x16x32_bf16 v[224:227], v[204:207], v[82:85], v[224:227]
    v_mfma_f32_16x16x32_bf16 v[228:231], v[204:207], v[86:89], v[228:231]
    v_mfma_f32_16x16x32_bf16 v[216:219], v[208:211], v[90:93], v[216:219]
    v_mfma_f32_16x16x32_bf16 v[220:223], v[208:211], v[94:97], v[220:223]
    v_mfma_f32_16x16x32_bf16 v[224:227], v[208:211], v[98:101], v[224:227]
    v_mfma_f32_16x16x32_bf16 v[228:231], v[208:211], v[102:105], v[228:231]
    v_mfma_f32_16x16x32_bf16 v[216:219], v[212:215], v[106:109], v[216:219]
    v_mfma_f32_16x16x32_bf16 v[220:223], v[212:215], v[110:113], v[220:223]
    v_mfma_f32_16x16x32_bf16 v[224:227], v[212:215], v[114:117], v[224:227]
    v_mfma_f32_16x16x32_bf16 v[228:231], v[212:215], v[118:121], v[228:231]
    s_lshl_b32 s69, s47, 8
    s_add_u32 s69, s69, 155648
    v_lshlrev_b32 v196, 4, v1
    v_add_u32 v196, s69, v196
    v_and_b32 v197, 3, v1
    v_lshl_add_u32 v197, v2, 2, v197
    v_lshlrev_b32 v197, 4, v197
    v_add_u32 v197, 155648, v197
    v_cmp_u_f32 vcc, v216, v216
    v_mov_b32 v217, v220
    v_mov_b32 v218, v224
    v_mov_b32 v219, v228
    s_cbranch_vccnz L_rretry
    s_mov_b64 exec, 0xFFFF
    ds_write_b128 v196, v[216:219]
    s_mov_b64 exec, -1
    s_waitcnt lgkmcnt(0)
    s_barrier
    ds_read_b128 v[200:203], v197 offset:0
    ds_read_b128 v[204:207], v197 offset:256
    ds_read_b128 v[208:211], v197 offset:512
    ds_read_b128 v[212:215], v197 offset:768
    s_and_b32 s68, s51, 31
    s_lshl3_add_u32 s68, s68, s55
    s_lshr_b32 s69, s51, 5
    s_lshl1_add_u32 s68, s68, s69
    s_lshl2_add_u32 s68, s68, s47
    s_lshl_b32 s68, s68, 8
    s_add_u32 s68, s68, 534528
    s_waitcnt lgkmcnt(0)
    v_pk_add_f32 v[200:201], v[200:201], v[204:205]
    v_pk_add_f32 v[208:209], v[208:209], v[212:213]
    v_pk_add_f32 v[202:203], v[202:203], v[206:207]
    v_pk_add_f32 v[210:211], v[210:211], v[214:215]
    v_pk_add_f32 v[200:201], v[200:201], v[208:209]
    v_pk_add_f32 v[202:203], v[202:203], v[210:211]
    v_mul_f32 v204, 0xBFB8AA3B, v200
    v_mul_f32 v205, 0xBFB8AA3B, v201
    v_exp_f32 v204, v204
    v_exp_f32 v205, v205
    v_pk_mul_f32 v[200:201], v[200:201], v[202:203]
    v_add_f32 v204, 1.0, v204
    v_add_f32 v205, 1.0, v205
    v_rcp_f32 v204, v204
    v_rcp_f32 v205, v205
    s_nop 0
    v_pk_mul_f32 v[200:201], v[200:201], v[204:205]
    v_cvt_pk_bf16_f32 v200, v200, v201
    s_nop 1
    v_mov_b32_dpp v204, v200 quad_perm:[0,0,0,0] row_mask:0xf bank_mask:0xf
    v_mov_b32_dpp v205, v200 quad_perm:[1,1,1,1] row_mask:0xf bank_mask:0xf
    v_mov_b32_dpp v206, v200 quad_perm:[2,2,2,2] row_mask:0xf bank_mask:0xf
    v_mov_b32_dpp v207, v200 quad_perm:[3,3,3,3] row_mask:0xf bank_mask:0xf
    s_nop 1
    v_mfma_f32_16x16x32_bf16 v[212:215], v[204:207], a[224:227], 0
    v_mfma_f32_16x16x32_bf16 v[216:219], v[204:207], a[228:231], 0
    v_mfma_f32_16x16x32_bf16 v[220:223], v[204:207], a[232:235], 0
    v_mfma_f32_16x16x32_bf16 v[224:227], v[204:207], a[236:239], 0
    v_mfma_f32_16x16x32_bf16 v[228:231], v[204:207], a[240:243], 0
    v_mfma_f32_16x16x32_bf16 v[232:235], v[204:207], a[244:247], 0
    v_mfma_f32_16x16x32_bf16 v[236:239], v[204:207], a[248:251], 0
    v_mfma_f32_16x16x32_bf16 v[240:243], v[204:207], a[252:255], 0
    s_nop 1
    v_cvt_pk_bf16_f32 v200, v212, v216
    s_nop 0
    v_cvt_pk_bf16_f32 v201, v220, v224
    s_nop 0
    v_cvt_pk_bf16_f32 v202, v228, v232
    s_nop 0
    v_cvt_pk_bf16_f32 v203, v236, v240
    s_mov_b64 exec, 0xFFFF
    buffer_store_dwordx4 v[200:203], v3, s[16:19], s68 offen sc1
    s_mov_b64 exec, -1
    s_cmp_eq_u32 s55, 0
    s_cbranch_scc1 L_join_t2
    s_branch L_ffn_done
L_rretry:
    buffer_load_dwordx4 v[200:203], v244, s[16:19], s68 offen offset:0 sc1
    buffer_load_dwordx4 v[204:207], v244, s[16:19], s68 offen offset:64 sc1
    buffer_load_dwordx4 v[208:211], v244, s[16:19], s68 offen offset:128 sc1
    buffer_load_dwordx4 v[212:215], v244, s[16:19], s68 offen offset:192 sc1
    s_sub_u32 s53, s53, 1
    s_cbranch_scc0 L_slow_rchk
    s_branch L_exit
L_slow_h:
    buffer_load_dwordx4 v[240:243], v252, s[16:19], 0 offen sc1
    s_sub_u32 s53, s53, 1
    s_cbranch_scc1 L_exit
    s_waitcnt vmcnt(0)
    v_cmp_ne_u32 vcc, s88, v243
    s_cbranch_vccnz L_slow_h
    buffer_load_dwordx4 v[244:247], v253, s[16:19], s92 offen sc1
    buffer_load_dwordx4 v[248:251], v253, s[16:19], s93 offen sc1
    s_waitcnt vmcnt(0)
    s_branch L_join_h
L_slow_hr:
    buffer_load_dwordx4 v[244:247], v253, s[16:19], s92 offen sc1
    buffer_load_dwordx4 v[248:251], v253, s[16:19], s93 offen sc1
    s_sub_u32 s53, s53, 1
    s_cbranch_scc1 L_exit
    s_waitcnt vmcnt(0)
    v_max3_u32 v243, v244, v245, v246
    v_max3_u32 v243, v243, v247, v248
    v_max3_u32 v243, v243, v249, v250
    v_max_u32 v243, v243, v251
    v_cmp_eq_u32 vcc, -1, v243
    s_cbranch_vccnz L_slow_hr
    s_branch L_join_hr
L_slow_13:
    buffer_store_dwordx4 v[236:239], v12, s[40:43], s65 offen sc1
    s_branch L_join_14
L_bslow:
    v_lshlrev_b32 v242, 7, v0
    v_mov_b32 v240, 0
    s_lshl_b32 s67, s55, 12
    s_add_u32 s67, s67, 196608
    s_mul_i32 s69, s55, 3
    s_add_u32 s69, s69, s49
    s_add_u32 s69, s69, 2
    s_mov_b32 exec_hi, 0
L_bpoll2:
    buffer_load_dwordx2 v[240:241], v242, s[16:19], s67 offen sc1
    s_sub_u32 s53, s53, 1
    s_cbranch_scc1 L_exit
    s_waitcnt vmcnt(0)
    v_cmp_ne_u32 vcc, s69, v241
    s_and_b64 exec, exec, vcc
    s_cbranch_scc1 L_bpoll2
    s_mov_b64 exec, -1
    v_max_u32_dpp v243, v240, v240 row_ror:8 row_mask:0xf bank_mask:0xf
    s_nop 1
    v_max_u32_dpp v243, v243, v243 row_ror:4 row_mask:0xf bank_mask:0xf
    s_nop 1
    v_max_u32_dpp v243, v243, v243 row_ror:2 row_mask:0xf bank_mask:0xf
    s_nop 1
    v_max_u32_dpp v243, v243, v243 row_ror:1 row_mask:0xf bank_mask:0xf
    s_nop 0
    v_readlane_b32 s66, v243, 0
    v_readlane_b32 s82, v243, 16
    s_max_u32 s82, s66, s82
    s_branch L_bok
L_slow_15:
    buffer_store_dwordx4 v[236:239], v254, s[40:43], 0 offen sc1
    s_branch L_join_16
L_slow_17:
    buffer_store_dwordx4 v[236:239], v254, s[40:43], 0 offen sc1
    s_branch L_join_18
L_ypoll_r:
    s_mov_b32 s3, 0
    buffer_load_dwordx4 a[192:195], v240, s[16:19], s3 offen sc1
    s_mov_b32 s3, 65536
    buffer_load_dwordx4 a[196:199], v240, s[16:19], s3 offen sc1
    s_mov_b32 s3, 131072
    buffer_load_dwordx4 a[200:203], v240, s[16:19], s3 offen sc1
    s_mov_b32 s3, 196608
    buffer_load_dwordx4 a[204:207], v240, s[16:19], s3 offen sc1
    s_mov_b32 s3, 262144
    buffer_load_dwordx4 a[208:211], v240, s[16:19], s3 offen sc1
    s_mov_b32 s3, 327680
    buffer_load_dwordx4 a[212:215], v240, s[16:19], s3 offen sc1
    s_mov_b32 s3, 393216
    buffer_load_dwordx4 a[216:219], v240, s[16:19], s3 offen sc1
    s_mov_b32 s3, 458752
    buffer_load_dwordx4 a[220:223], v240, s[16:19], s3 offen sc1
    s_mov_b32 s3, 1024
    buffer_load_dwordx4 v[168:171], v240, s[16:19], s3 offen sc1
    s_mov_b32 s3, 66560
    buffer_load_dwordx4 v[172:175], v240, s[16:19], s3 offen sc1
    s_mov_b32 s3, 132096
    buffer_load_dwordx4 v[176:179], v241, s[16:19], s3 offen sc1
    s_sub_u32 s53, s53, 1
    s_cbranch_scc0 L_ypoll
    s_branch L_exit
L_slow_19:
    buffer_store_dwordx4 v[236:239], v142, s[40:43], 0 offen sc1
    s_branch L_join_20
L_zpoll_r:
    s_mov_b32 s3, 0
    buffer_load_dwordx4 a[192:195], v240, s[16:19], s3 offen sc1
    s_mov_b32 s3, 131072
    buffer_load_dwordx4 a[196:199], v240, s[16:19], s3 offen sc1
    s_mov_b32 s3, 262144
    buffer_load_dwordx4 a[200:203], v240, s[16:19], s3 offen sc1
    s_mov_b32 s3, 393216
    buffer_load_dwordx4 a[204:207], v240, s[16:19], s3 offen sc1
    s_mov_b32 s3, 1024
    buffer_load_dwordx4 a[208:211], v240, s[16:19], s3 offen sc1
    s_mov_b32 s3, 132096
    buffer_load_dwordx4 a[212:215], v241, s[16:19], s3 offen sc1
    s_sub_u32 s53, s53, 1
    s_cbranch_scc0 L_zpoll
    s_branch L_exit
L_last:
    s_endpgm
.section .rodata,"a"
.p2align 6
.amdhsa_kernel interleave_layers__sliding_local_dilated__moe_arch_mod__prompt_kernel
  .amdhsa_next_free_vgpr 512
  .amdhsa_next_free_sgpr 102
  .amdhsa_accum_offset 256
  .amdhsa_group_segment_fixed_size 0
  .amdhsa_kernarg_size 88
  .amdhsa_user_sgpr_count 2
  .amdhsa_user_sgpr_kernarg_segment_ptr 1
  .amdhsa_system_sgpr_workgroup_id_x 1
  .amdhsa_float_denorm_mode_32 3
.end_amdhsa_kernel
```
